```python
import torch

def _softmax(x, axis=-1):
    return torch.softmax(x, dim=axis)

def _gelu(x):
    return torch.nn.functional.gelu(x, approximate='tanh')

def _silu(x):
    return torch.nn.functional.silu(x)

def _sigmoid(x):
    return torch.sigmoid(x)

def _layernorm(x, axis=-1, eps=1e-05):
    m = x.mean(dim=axis, keepdim=True)
    v = x.var(dim=axis, keepdim=True, unbiased=False)
    return (x - m) / torch.sqrt(v + eps)

def _scatter_add(tgt, idx, src, axis=0):
    return tgt.clone().index_add_(axis, idx, src)

def _segment_sum(src, seg, n):
    out = torch.zeros((n,) + src.shape[1:], dtype=src.dtype)
    return out.index_add_(0, seg, src)

def _pad(x, pw):
    flat = tuple((v for pair in reversed(pw) for v in pair))
    return torch.nn.functional.pad(x, flat)
kernel_name = 'standalone__tree_speculative_verify_tree_attention_over_candidate_token_tree__sampling'

def setup_inputs():

    _w = lambda a: (lambda t: t.to(torch.bfloat16) if t.is_floating_point() else t)(torch.as_tensor(a))
    B, Hq, Hkv, T, C, D = (16, 16, 8, 16, 4096, 256)
    tree_mask = torch.zeros((B, T, T), dtype=float)
    for b in range(B):
        parent = torch.zeros(T, dtype=torch.int64)
        for i in range(1, T):
            parent[i] = int(torch.randint(0, i, (1,)).item())
        for i in range(T):
            j = i
            tree_mask[b, i, j] = 1.0
            while j > 0:
                j = parent[j]
                tree_mask[b, i, j] = 1.0
    return {'q': _w((lambda *s: torch.randn(*s, dtype=torch.bfloat16) * 0.8)(B, Hq, T, D)), 'k_cache': _w((lambda *s: torch.randn(*s, dtype=torch.bfloat16) * 0.8)(B, Hkv, C, D)), 'v_cache': _w((lambda *s: torch.randn(*s, dtype=torch.bfloat16) * 0.05)(B, Hkv, C, D)), 'k_tree': _w((lambda *s: torch.randn(*s, dtype=torch.bfloat16) * 0.8)(B, Hkv, T, D)), 'v_tree': _w((lambda *s: torch.randn(*s, dtype=torch.bfloat16) * 0.05)(B, Hkv, T, D)), 'tree_mask': _w(tree_mask)}

def reference(q, k_cache, v_cache, k_tree, v_tree, tree_mask):
    B, Hq, T, D = q.shape
    Hkv, C = (k_cache.shape[1], k_cache.shape[2])
    rep = Hq // Hkv
    kc = (lambda x, n, axis: torch.repeat_interleave(x, n, dim=axis))(k_cache, rep, axis=1)
    vc = (lambda x, n, axis: torch.repeat_interleave(x, n, dim=axis))(v_cache, rep, axis=1)
    kt = (lambda x, n, axis: torch.repeat_interleave(x, n, dim=axis))(k_tree, rep, axis=1)
    vt = (lambda x, n, axis: torch.repeat_interleave(x, n, dim=axis))(v_tree, rep, axis=1)
    k = torch.concatenate([kc, kt], axis=2)
    v = torch.concatenate([vc, vt], axis=2)
    scale = D ** (-0.5)
    scores = torch.einsum('bhqd,bhkd->bhqk', q, k) * scale
    ctx_mask = torch.ones((B, 1, T, C), dtype=scores.dtype)
    tm = tree_mask[:, None, :, :].clone()
    full_mask = torch.concatenate([ctx_mask, tm], axis=-1)
    scores = scores + (1.0 - full_mask) * -1000000000.0
    p = _softmax(scores, axis=-1)
    return torch.einsum('bhqk,bhkd->bhqd', p, v)
```

```asm
; @launch grid=(256,1,1) block=(256,1,1) lds=157696
.amdgcn_target "amdgcn-amd-amdhsa--gfx950"
.text
.globl standalone__tree_speculative_verify_tree_attention_over_candidate_token_tree__sampling_kernel
.p2align 8
.type standalone__tree_speculative_verify_tree_attention_over_candidate_token_tree__sampling_kernel,@function
standalone__tree_speculative_verify_tree_attention_over_candidate_token_tree__sampling_kernel:
    s_cmp_ge_u32 s2, 256
    s_cbranch_scc1 L_end
    s_load_dwordx16 s[4:19], s[0:1], 0
    s_load_dwordx2 s[20:21], s[0:1], 64
    v_lshrrev_b32 v9, 6, v0
    v_and_b32 v1, 63, v0
    v_readfirstlane_b32 s22, v9
    v_lshlrev_b32 v2, 4, v1
    v_and_b32 v10, 31, v1
    v_lshrrev_b32 v11, 5, v1
    v_and_b32 v12, 3, v10
    v_lshrrev_b32 v13, 3, v10
    v_lshl_add_u32 v12, v13, 2, v12
    v_bfe_u32 v13, v10, 2, 1
    v_lshl_add_u32 v16, v12, 1, v13
    v_mul_u32_u24 v12, 1040, v12
    v_lshl_add_u32 v12, v13, 9, v12
    v_lshl_add_u32 v12, v11, 4, v12
    s_mul_i32 s60, s22, 16640
    v_add_u32 v4, s60, v12
    v_add_u32 v14, 66560, v12
    v_bfe_u32 v15, v10, 2, 1
    v_lshlrev_b32 v15, 9, v15
    v_lshl_add_u32 v15, v11, 4, v15
    s_lshl_b32 s68, s22, 10
    s_add_u32 s69, s68, 83200
    v_add_u32 v15, s69, v15
    v_and_b32 v17, 15, v16
    v_lshlrev_b32 v17, 5, v17
    v_lshl_add_u32 v17, v11, 1, v17
    v_lshlrev_b32 v18, 9, v16
    v_lshl_add_u32 v18, v11, 6, v18
    s_lshr_b32 s70, s2, 1
    s_and_b32 s71, s2, 1
    s_lshl_b32 s72, s71, 2
    s_add_u32 s72, s72, s22
    s_lshl_b32 s65, s71, 16
    s_xor_b32 s66, s65, 0x10000
    s_lshl_b32 s73, s70, 14
    s_lshl_b32 s74, s70, 13
    s_lshr_b32 s75, s70, 3
    s_lshl_b32 s75, s75, 9
    s_lshl_b32 s76, s70, 17
    s_lshl_b32 s77, s70, 21
    s_mov_b32 s61, 0
    s_lshl_b32 s56, s22, 13
    s_lshl_b32 s78, s71, 12
    s_add_u32 s56, s56, s78
    s_add_u32 s59, s56, 98304
    s_add_u32 s58, s56, 65536
    s_add_u32 s57, s56, 32768
    s_mov_b32 s62, 0x3db8aa3b
    s_mov_b32 s63, 0x05040100
    s_mov_b32 s64, 0x07060302
    s_waitcnt lgkmcnt(0)
    s_add_u32 s24, s6, s77
    s_addc_u32 s25, s7, 0
    s_mov_b32 s26, 2097152
    s_mov_b32 s27, 0x20000
    s_add_u32 m0, s60, 0
    s_nop 0
    buffer_load_dwordx4 v2, s[24:27], s56 offen offset:0 nt lds
    s_add_u32 s32, s4, s73
    s_addc_u32 s33, s5, 0
    s_mov_b32 s34, 16384
    s_mov_b32 s35, 0x20000
    s_lshl_b32 s78, s22, 12
    s_mul_i32 s79, s22, 4160
    s_add_u32 s79, s79, 66560
    s_add_u32 m0, s79, 0
    s_nop 0
    buffer_load_dwordx4 v2, s[32:35], s78 offen offset:0  lds
    s_add_u32 m0, s79, 16
    s_nop 0
    buffer_load_dwordx4 v2, s[32:35], s78 offen offset:1024  lds
    s_add_u32 m0, s79, 32
    s_nop 0
    buffer_load_dwordx4 v2, s[32:35], s78 offen offset:2048  lds
    s_add_u32 m0, s79, 48
    s_nop 0
    buffer_load_dwordx4 v2, s[32:35], s78 offen offset:3072  lds
    s_add_u32 m0, s60, 16
    s_nop 0
    buffer_load_dwordx4 v2, s[24:27], s56 offen offset:1024 nt lds
    s_add_u32 m0, s60, 32
    s_nop 0
    buffer_load_dwordx4 v2, s[24:27], s56 offen offset:2048 nt lds
    s_add_u32 m0, s60, 48
    s_nop 0
    buffer_load_dwordx4 v2, s[24:27], s56 offen offset:3072 nt lds
    s_add_u32 m0, s60, 4160
    s_nop 0
    buffer_load_dwordx4 v2, s[24:27], s57 offen offset:0 nt lds
    s_add_u32 s28, s8, s77
    s_addc_u32 s29, s9, 0
    s_mov_b32 s30, 2097152
    s_mov_b32 s31, 0x20000
    s_add_u32 s67, s72, 1
    v_mov_b32 v12, 0
    v_mov_b32 v9, 101376
    s_cmp_lg_u32 s22, 0
    s_cbranch_scc1 L_noclear
    s_mov_b64 exec, 1
    ds_write_b32 v9, v12
    s_mov_b64 exec, -1
L_noclear:
    s_waitcnt vmcnt(8)
    s_add_u32 m0, s60, 4176
    s_nop 0
    buffer_load_dwordx4 v2, s[24:27], s57 offen offset:1024 nt lds
    v_mov_b32 v128, 0
    v_mov_b32 v129, 0
    v_mov_b32 v130, 0
    v_mov_b32 v131, 0
    v_mov_b32 v132, 0
    v_mov_b32 v133, 0
    v_mov_b32 v134, 0
    v_mov_b32 v135, 0
    v_mov_b32 v136, 0
    v_mov_b32 v137, 0
    v_mov_b32 v138, 0
    v_mov_b32 v139, 0
    v_mov_b32 v140, 0
    v_mov_b32 v141, 0
    v_mov_b32 v142, 0
    v_mov_b32 v143, 0
    v_mov_b32 v144, 0
    v_mov_b32 v145, 0
    v_mov_b32 v146, 0
    v_mov_b32 v147, 0
    v_mov_b32 v148, 0
    v_mov_b32 v149, 0
    s_waitcnt vmcnt(4)
    s_add_u32 m0, s60, 4192
    s_nop 0
    buffer_load_dwordx4 v2, s[24:27], s57 offen offset:2048 nt lds
    v_mov_b32 v150, 0
    v_mov_b32 v151, 0
    v_mov_b32 v152, 0
    v_mov_b32 v153, 0
    v_mov_b32 v154, 0
    v_mov_b32 v155, 0
    v_mov_b32 v156, 0
    v_mov_b32 v157, 0
    v_mov_b32 v158, 0
    v_mov_b32 v159, 0
    v_mov_b32 v160, 0
    v_mov_b32 v161, 0
    v_mov_b32 v162, 0
    v_mov_b32 v163, 0
    v_mov_b32 v164, 0
    v_mov_b32 v165, 0
    v_mov_b32 v166, 0
    v_mov_b32 v167, 0
    v_mov_b32 v168, 0
    v_mov_b32 v169, 0
    v_mov_b32 v170, 0
    v_mov_b32 v171, 0
    s_waitcnt vmcnt(4)
    s_add_u32 m0, s60, 4208
    s_nop 0
    buffer_load_dwordx4 v2, s[24:27], s57 offen offset:3072 nt lds
    v_mov_b32 v172, 0
    v_mov_b32 v173, 0
    v_mov_b32 v174, 0
    v_mov_b32 v175, 0
    v_mov_b32 v176, 0
    v_mov_b32 v177, 0
    v_mov_b32 v178, 0
    v_mov_b32 v179, 0
    v_mov_b32 v180, 0
    v_mov_b32 v181, 0
    v_mov_b32 v182, 0
    v_mov_b32 v183, 0
    v_mov_b32 v184, 0
    v_mov_b32 v185, 0
    v_mov_b32 v186, 0
    v_mov_b32 v187, 0
    v_mov_b32 v188, 0
    v_mov_b32 v189, 0
    v_mov_b32 v190, 0
    v_mov_b32 v191, 0
    v_mov_b32 v192, 0
    v_mov_b32 v193, 0
    s_waitcnt vmcnt(4)
    s_add_u32 m0, s60, 8320
    s_nop 0
    buffer_load_dwordx4 v2, s[24:27], s58 offen offset:0 nt lds
    v_mov_b32 v194, 0
    v_mov_b32 v195, 0
    v_mov_b32 v196, 0
    v_mov_b32 v197, 0
    v_mov_b32 v198, 0
    v_mov_b32 v199, 0
    v_mov_b32 v200, 0
    v_mov_b32 v201, 0
    v_mov_b32 v202, 0
    v_mov_b32 v203, 0
    v_mov_b32 v204, 0
    v_mov_b32 v205, 0
    v_mov_b32 v206, 0
    v_mov_b32 v207, 0
    v_mov_b32 v208, 0
    v_mov_b32 v209, 0
    v_mov_b32 v210, 0
    v_mov_b32 v211, 0
    v_mov_b32 v212, 0
    v_mov_b32 v213, 0
    v_mov_b32 v214, 0
    v_mov_b32 v215, 0
    s_waitcnt vmcnt(4)
    s_add_u32 m0, s60, 8336
    s_nop 0
    buffer_load_dwordx4 v2, s[24:27], s58 offen offset:1024 nt lds
    v_mov_b32 v216, 0
    v_mov_b32 v217, 0
    v_mov_b32 v218, 0
    v_mov_b32 v219, 0
    v_mov_b32 v220, 0
    v_mov_b32 v221, 0
    v_mov_b32 v222, 0
    v_mov_b32 v223, 0
    v_mov_b32 v224, 0
    v_mov_b32 v225, 0
    v_mov_b32 v226, 0
    v_mov_b32 v227, 0
    v_mov_b32 v228, 0
    v_mov_b32 v229, 0
    v_mov_b32 v230, 0
    v_mov_b32 v231, 0
    v_mov_b32 v232, 0
    v_mov_b32 v233, 0
    v_mov_b32 v234, 0
    v_mov_b32 v235, 0
    v_mov_b32 v236, 0
    v_mov_b32 v237, 0
    s_waitcnt vmcnt(4)
    s_add_u32 m0, s60, 8352
    s_nop 0
    buffer_load_dwordx4 v2, s[24:27], s58 offen offset:2048 nt lds
    v_mov_b32 v238, 0
    v_mov_b32 v239, 0
    v_mov_b32 v240, 0
    v_mov_b32 v241, 0
    v_mov_b32 v242, 0
    v_mov_b32 v243, 0
    v_mov_b32 v244, 0
    v_mov_b32 v245, 0
    v_mov_b32 v246, 0
    v_mov_b32 v247, 0
    v_mov_b32 v248, 0
    v_mov_b32 v249, 0
    v_mov_b32 v250, 0
    v_mov_b32 v251, 0
    v_mov_b32 v252, 0
    v_mov_b32 v253, 0
    v_mov_b32 v254, 0
    v_mov_b32 v255, 0
    v_mov_b32 v5, 0xff800000
    v_mov_b32 v6, 0
    s_waitcnt vmcnt(4)
    s_add_u32 m0, s60, 8368
    s_nop 0
    buffer_load_dwordx4 v2, s[24:27], s58 offen offset:3072 nt lds
    s_waitcnt lgkmcnt(0)
    s_barrier
    ds_read_b128 a[0:3], v14 offset:0
    ds_read_b128 a[4:7], v14 offset:32
    ds_read_b128 a[8:11], v14 offset:64
    ds_read_b128 a[12:15], v14 offset:96
    ds_read_b128 a[16:19], v14 offset:128
    ds_read_b128 a[20:23], v14 offset:160
    ds_read_b128 a[24:27], v14 offset:192
    ds_read_b128 a[28:31], v14 offset:224
    s_waitcnt vmcnt(4)
    s_add_u32 m0, s60, 12480
    s_nop 0
    buffer_load_dwordx4 v2, s[24:27], s59 offen offset:0 nt lds
    s_waitcnt lgkmcnt(0)
    ds_read_b128 a[32:35], v14 offset:256
    ds_read_b128 a[36:39], v14 offset:288
    ds_read_b128 a[40:43], v14 offset:320
    ds_read_b128 a[44:47], v14 offset:352
    ds_read_b128 a[48:51], v14 offset:384
    ds_read_b128 a[52:55], v14 offset:416
    ds_read_b128 a[56:59], v14 offset:448
    ds_read_b128 a[60:63], v14 offset:480
    s_waitcnt vmcnt(4)
    s_add_u32 m0, s60, 12496
    s_nop 0
    buffer_load_dwordx4 v2, s[24:27], s59 offen offset:1024 nt lds
    s_waitcnt lgkmcnt(0)
    s_waitcnt vmcnt(4)
    s_add_u32 m0, s60, 12512
    s_nop 0
    buffer_load_dwordx4 v2, s[24:27], s59 offen offset:2048 nt lds
    s_waitcnt vmcnt(4)
    s_add_u32 m0, s60, 12528
    s_nop 0
    buffer_load_dwordx4 v2, s[24:27], s59 offen offset:3072 nt lds
.p2align 6
L_loop:
    s_waitcnt vmcnt(4)
    buffer_load_dwordx4 v[64:67], v2, s[28:31], s56 offen offset:0 nt
    s_waitcnt vmcnt(4)
    buffer_load_dwordx4 v[68:71], v2, s[28:31], s56 offen offset:1024 nt
    s_waitcnt vmcnt(4)
    buffer_load_dwordx4 v[72:75], v2, s[28:31], s56 offen offset:2048 nt
    s_waitcnt vmcnt(4)
    buffer_load_dwordx4 v[76:79], v2, s[28:31], s56 offen offset:3072 nt
    s_waitcnt vmcnt(4)
    buffer_load_dwordx4 v[80:83], v2, s[28:31], s57 offen offset:0 nt
    ds_read_b128 a[64:67], v4 offset:0
    ds_read_b128 a[68:71], v4 offset:32
    ds_read_b128 a[72:75], v4 offset:64
    ds_read_b128 a[76:79], v4 offset:96
    ds_read_b128 a[80:83], v4 offset:128
    ds_read_b128 a[84:87], v4 offset:160
    ds_read_b128 a[88:91], v4 offset:192
    ds_read_b128 a[92:95], v4 offset:224
    s_waitcnt vmcnt(4)
    buffer_load_dwordx4 v[84:87], v2, s[28:31], s57 offen offset:1024 nt
    s_waitcnt lgkmcnt(0)
    ds_read_b128 a[96:99], v4 offset:256
    ds_read_b128 a[100:103], v4 offset:288
    ds_read_b128 a[104:107], v4 offset:320
    ds_read_b128 a[108:111], v4 offset:352
    ds_read_b128 a[112:115], v4 offset:384
    ds_read_b128 a[116:119], v4 offset:416
    ds_read_b128 a[120:123], v4 offset:448
    ds_read_b128 a[124:127], v4 offset:480
    v_mfma_f32_32x32x16_bf16 v[32:47], a[64:67], a[0:3], 0
    v_mfma_f32_32x32x16_bf16 v[32:47], a[68:71], a[4:7], v[32:47]
    v_mfma_f32_32x32x16_bf16 v[32:47], a[72:75], a[8:11], v[32:47]
    v_mfma_f32_32x32x16_bf16 v[32:47], a[76:79], a[12:15], v[32:47]
    s_waitcnt vmcnt(4)
    buffer_load_dwordx4 v[88:91], v2, s[28:31], s57 offen offset:2048 nt
    v_mfma_f32_32x32x16_bf16 v[32:47], a[80:83], a[16:19], v[32:47]
    v_mfma_f32_32x32x16_bf16 v[32:47], a[84:87], a[20:23], v[32:47]
    v_mfma_f32_32x32x16_bf16 v[32:47], a[88:91], a[24:27], v[32:47]
    v_mfma_f32_32x32x16_bf16 v[32:47], a[92:95], a[28:31], v[32:47]
    s_waitcnt vmcnt(4)
    buffer_load_dwordx4 v[92:95], v2, s[28:31], s57 offen offset:3072 nt
    s_waitcnt lgkmcnt(0)
    v_mfma_f32_32x32x16_bf16 v[32:47], a[96:99], a[32:35], v[32:47]
    v_mfma_f32_32x32x16_bf16 v[32:47], a[100:103], a[36:39], v[32:47]
    v_mfma_f32_32x32x16_bf16 v[32:47], a[104:107], a[40:43], v[32:47]
    v_mfma_f32_32x32x16_bf16 v[32:47], a[108:111], a[44:47], v[32:47]
    s_waitcnt vmcnt(4)
    buffer_load_dwordx4 v[96:99], v2, s[28:31], s58 offen offset:0 nt
    v_mfma_f32_32x32x16_bf16 v[32:47], a[112:115], a[48:51], v[32:47]
    v_mfma_f32_32x32x16_bf16 v[32:47], a[116:119], a[52:55], v[32:47]
    v_mfma_f32_32x32x16_bf16 v[32:47], a[120:123], a[56:59], v[32:47]
    v_mfma_f32_32x32x16_bf16 v[32:47], a[124:127], a[60:63], v[32:47]
    s_waitcnt vmcnt(4)
    buffer_load_dwordx4 v[100:103], v2, s[28:31], s58 offen offset:1024 nt
    s_nop 11
    v_max3_f32 v9, v32, v33, v34
    v_max3_f32 v10, v35, v36, v37
    v_max3_f32 v9, v9, v38, v39
    v_max3_f32 v10, v10, v40, v41
    v_max3_f32 v9, v9, v42, v43
    v_max3_f32 v10, v10, v44, v45
    v_max3_f32 v9, v9, v46, v47
    v_max_f32 v9, v9, v10
    v_mov_b32 v10, v9
    s_nop 1
    v_permlane32_swap_b32 v9, v10
    s_nop 1
    v_max_f32 v9, v9, v10
    v_mul_f32 v9, s62, v9
    v_max_f32 v8, v5, v9
    v_sub_f32 v10, v5, v8
    v_exp_f32 v7, v10
    v_cmp_gt_f32 vcc, v8, v5
    v_mov_b32 v5, v8
    v_mul_f32 v6, v6, v7
    s_nop 1
    s_waitcnt vmcnt(4)
    buffer_load_dwordx4 v[104:107], v2, s[28:31], s58 offen offset:2048 nt
    s_cbranch_vccz L_skip_loop_0
    v_mul_f32 v128, v7, v128
    v_mul_f32 v129, v7, v129
    v_mul_f32 v130, v7, v130
    v_mul_f32 v131, v7, v131
    v_mul_f32 v132, v7, v132
    v_mul_f32 v133, v7, v133
    v_mul_f32 v134, v7, v134
    v_mul_f32 v135, v7, v135
    v_mul_f32 v136, v7, v136
    v_mul_f32 v137, v7, v137
    v_mul_f32 v138, v7, v138
    v_mul_f32 v139, v7, v139
    v_mul_f32 v140, v7, v140
    v_mul_f32 v141, v7, v141
    v_mul_f32 v142, v7, v142
    v_mul_f32 v143, v7, v143
    v_mul_f32 v144, v7, v144
    v_mul_f32 v145, v7, v145
    v_mul_f32 v146, v7, v146
    v_mul_f32 v147, v7, v147
    v_mul_f32 v148, v7, v148
    v_mul_f32 v149, v7, v149
    v_mul_f32 v150, v7, v150
    v_mul_f32 v151, v7, v151
    v_mul_f32 v152, v7, v152
    v_mul_f32 v153, v7, v153
    v_mul_f32 v154, v7, v154
    v_mul_f32 v155, v7, v155
    v_mul_f32 v156, v7, v156
    v_mul_f32 v157, v7, v157
    v_mul_f32 v158, v7, v158
    v_mul_f32 v159, v7, v159
    v_mul_f32 v160, v7, v160
    v_mul_f32 v161, v7, v161
    v_mul_f32 v162, v7, v162
    v_mul_f32 v163, v7, v163
    v_mul_f32 v164, v7, v164
    v_mul_f32 v165, v7, v165
    v_mul_f32 v166, v7, v166
    v_mul_f32 v167, v7, v167
    v_mul_f32 v168, v7, v168
    v_mul_f32 v169, v7, v169
    v_mul_f32 v170, v7, v170
    v_mul_f32 v171, v7, v171
    v_mul_f32 v172, v7, v172
    v_mul_f32 v173, v7, v173
    v_mul_f32 v174, v7, v174
    v_mul_f32 v175, v7, v175
    v_mul_f32 v176, v7, v176
    v_mul_f32 v177, v7, v177
    v_mul_f32 v178, v7, v178
    v_mul_f32 v179, v7, v179
    v_mul_f32 v180, v7, v180
    v_mul_f32 v181, v7, v181
    v_mul_f32 v182, v7, v182
    v_mul_f32 v183, v7, v183
    v_mul_f32 v184, v7, v184
    v_mul_f32 v185, v7, v185
    v_mul_f32 v186, v7, v186
    v_mul_f32 v187, v7, v187
    v_mul_f32 v188, v7, v188
    v_mul_f32 v189, v7, v189
    v_mul_f32 v190, v7, v190
    v_mul_f32 v191, v7, v191
L_skip_loop_0:
    s_waitcnt vmcnt(4)
    buffer_load_dwordx4 v[108:111], v2, s[28:31], s58 offen offset:3072 nt
    s_cbranch_vccz L_skip_loop_1
    v_mul_f32 v192, v7, v192
    v_mul_f32 v193, v7, v193
    v_mul_f32 v194, v7, v194
    v_mul_f32 v195, v7, v195
    v_mul_f32 v196, v7, v196
    v_mul_f32 v197, v7, v197
    v_mul_f32 v198, v7, v198
    v_mul_f32 v199, v7, v199
    v_mul_f32 v200, v7, v200
    v_mul_f32 v201, v7, v201
    v_mul_f32 v202, v7, v202
    v_mul_f32 v203, v7, v203
    v_mul_f32 v204, v7, v204
    v_mul_f32 v205, v7, v205
    v_mul_f32 v206, v7, v206
    v_mul_f32 v207, v7, v207
    v_mul_f32 v208, v7, v208
    v_mul_f32 v209, v7, v209
    v_mul_f32 v210, v7, v210
    v_mul_f32 v211, v7, v211
    v_mul_f32 v212, v7, v212
    v_mul_f32 v213, v7, v213
    v_mul_f32 v214, v7, v214
    v_mul_f32 v215, v7, v215
    v_mul_f32 v216, v7, v216
    v_mul_f32 v217, v7, v217
    v_mul_f32 v218, v7, v218
    v_mul_f32 v219, v7, v219
    v_mul_f32 v220, v7, v220
    v_mul_f32 v221, v7, v221
    v_mul_f32 v222, v7, v222
    v_mul_f32 v223, v7, v223
    v_mul_f32 v224, v7, v224
    v_mul_f32 v225, v7, v225
    v_mul_f32 v226, v7, v226
    v_mul_f32 v227, v7, v227
    v_mul_f32 v228, v7, v228
    v_mul_f32 v229, v7, v229
    v_mul_f32 v230, v7, v230
    v_mul_f32 v231, v7, v231
    v_mul_f32 v232, v7, v232
    v_mul_f32 v233, v7, v233
    v_mul_f32 v234, v7, v234
    v_mul_f32 v235, v7, v235
    v_mul_f32 v236, v7, v236
    v_mul_f32 v237, v7, v237
    v_mul_f32 v238, v7, v238
    v_mul_f32 v239, v7, v239
    v_mul_f32 v240, v7, v240
    v_mul_f32 v241, v7, v241
    v_mul_f32 v242, v7, v242
    v_mul_f32 v243, v7, v243
    v_mul_f32 v244, v7, v244
    v_mul_f32 v245, v7, v245
    v_mul_f32 v246, v7, v246
    v_mul_f32 v247, v7, v247
    v_mul_f32 v248, v7, v248
    v_mul_f32 v249, v7, v249
    v_mul_f32 v250, v7, v250
    v_mul_f32 v251, v7, v251
    v_mul_f32 v252, v7, v252
    v_mul_f32 v253, v7, v253
    v_mul_f32 v254, v7, v254
    v_mul_f32 v255, v7, v255
L_skip_loop_1:
    s_waitcnt vmcnt(4)
    buffer_load_dwordx4 v[112:115], v2, s[28:31], s59 offen offset:0 nt
    v_fma_f32 v32, v32, s62, -v5
    v_fma_f32 v33, v33, s62, -v5
    v_fma_f32 v34, v34, s62, -v5
    v_fma_f32 v35, v35, s62, -v5
    v_fma_f32 v36, v36, s62, -v5
    v_fma_f32 v37, v37, s62, -v5
    v_fma_f32 v38, v38, s62, -v5
    v_fma_f32 v39, v39, s62, -v5
    v_exp_f32 v32, v32
    v_exp_f32 v33, v33
    v_exp_f32 v34, v34
    v_exp_f32 v35, v35
    v_exp_f32 v36, v36
    v_exp_f32 v37, v37
    v_exp_f32 v38, v38
    v_exp_f32 v39, v39
    s_nop 0
    v_cvt_pk_bf16_f32 v24, v32, v33
    v_cvt_pk_bf16_f32 v25, v34, v35
    v_cvt_pk_bf16_f32 v26, v36, v37
    v_cvt_pk_bf16_f32 v27, v38, v39
    v_add_f32 v9, v32, v33
    v_add_f32 v10, v34, v35
    v_add_f32 v9, v9, v36
    v_add_f32 v10, v10, v37
    v_add_f32 v9, v9, v38
    v_add_f32 v10, v10, v39
    v_add_f32 v9, v9, v10
    v_add_f32 v6, v6, v9
    s_waitcnt vmcnt(4)
    buffer_load_dwordx4 v[116:119], v2, s[28:31], s59 offen offset:1024 nt
    v_fma_f32 v40, v40, s62, -v5
    v_fma_f32 v41, v41, s62, -v5
    v_fma_f32 v42, v42, s62, -v5
    v_fma_f32 v43, v43, s62, -v5
    v_fma_f32 v44, v44, s62, -v5
    v_fma_f32 v45, v45, s62, -v5
    v_fma_f32 v46, v46, s62, -v5
    v_fma_f32 v47, v47, s62, -v5
    v_exp_f32 v40, v40
    v_exp_f32 v41, v41
    v_exp_f32 v42, v42
    v_exp_f32 v43, v43
    v_exp_f32 v44, v44
    v_exp_f32 v45, v45
    v_exp_f32 v46, v46
    v_exp_f32 v47, v47
    s_nop 0
    v_cvt_pk_bf16_f32 v28, v40, v41
    v_cvt_pk_bf16_f32 v29, v42, v43
    v_cvt_pk_bf16_f32 v30, v44, v45
    v_cvt_pk_bf16_f32 v31, v46, v47
    v_add_f32 v9, v40, v41
    v_add_f32 v10, v42, v43
    v_add_f32 v9, v9, v44
    v_add_f32 v10, v10, v45
    v_add_f32 v9, v9, v46
    v_add_f32 v10, v10, v47
    v_add_f32 v9, v9, v10
    v_add_f32 v6, v6, v9
    s_waitcnt vmcnt(4)
    buffer_load_dwordx4 v[120:123], v2, s[28:31], s59 offen offset:2048 nt
    s_waitcnt vmcnt(4)
    buffer_load_dwordx4 v[124:127], v2, s[28:31], s59 offen offset:3072 nt
    s_add_u32 s61, s61, 1
    s_add_u32 s56, s56, 131072
    s_add_u32 s57, s57, 131072
    s_add_u32 s58, s58, 131072
    s_add_u32 s59, s59, 131072
    s_cmp_lg_u32 s61, 15
    s_cbranch_scc1 L_tk_loop
    s_cmp_lg_u32 s22, 0
    s_cbranch_scc1 L_tk_loop
    s_lshr_b32 s78, s70, 1
    s_lshl_b32 s78, s78, 2
    s_and_b32 s79, s70, 1
    s_lshl_b32 s79, s79, 4
    s_lshl_b32 s80, 1, s79
    v_mov_b32 v12, s78
    v_mov_b32 v13, s80
    s_mov_b64 exec, 1
    global_atomic_add v13, v12, v13, s[18:19] sc0 sc1
    s_mov_b64 exec, -1
L_tk_loop:
    s_barrier
    s_waitcnt vmcnt(4)
    s_add_u32 m0, s60, 0
    s_nop 0
    buffer_load_dwordx4 v2, s[24:27], s56 offen offset:0 nt lds
    s_cmp_lg_u32 s61, s67
    s_cbranch_scc1 L_treeld_loop
    s_add_u32 s36, s10, s74
    s_addc_u32 s37, s11, 0
    s_mov_b32 s38, 8192
    s_mov_b32 s39, 0x20000
    s_add_u32 s40, s12, s74
    s_addc_u32 s41, s13, 0
    s_mov_b32 s42, 8192
    s_mov_b32 s43, 0x20000
    s_add_u32 s44, s14, s75
    s_addc_u32 s45, s15, 0
    s_mov_b32 s46, 512
    s_mov_b32 s47, 0x20000
    s_lshl_b32 s80, s72, 10
    s_lshl_b32 s81, s72, 2
    s_mov_b32 m0, s69
    s_nop 0
    buffer_load_dwordx4 v2, s[36:39], s80 offen lds
    buffer_load_dwordx4 v[20:23], v2, s[40:43], s80 offen
    buffer_load_ushort v19, v17, s[44:47], s81 offen
    s_cmp_lg_u32 s22, 0
    s_cbranch_scc1 L_treeld_loop
    s_add_u32 s52, s20, s76
    s_addc_u32 s53, s21, 0
    s_mov_b32 s54, 131072
    s_mov_b32 s55, 0x20000
    v_mov_b32 v10, 0
    v_mov_b32 v11, 0
    v_mov_b32 v12, 0
    v_mov_b32 v13, 0
    v_mov_b32 v9, 36864
    s_mov_b64 exec, 1
    buffer_store_dwordx4 v[10:13], v9, s[52:55], s65 offen sc1
    s_mov_b64 exec, -1
L_treeld_loop:
    v_perm_b32 v48, v68, v64, s63
    v_perm_b32 v49, v76, v72, s63
    v_perm_b32 v50, v84, v80, s63
    v_perm_b32 v51, v92, v88, s63
    v_perm_b32 v52, v68, v64, s64
    v_perm_b32 v53, v76, v72, s64
    v_perm_b32 v54, v84, v80, s64
    v_perm_b32 v55, v92, v88, s64
    s_nop 1
    v_mfma_f32_32x32x16_bf16 v[128:143], v[48:51], v[24:27], v[128:143]
    v_mfma_f32_32x32x16_bf16 v[144:159], v[52:55], v[24:27], v[144:159]
    s_waitcnt vmcnt(4)
    s_add_u32 m0, s60, 16
    s_nop 0
    buffer_load_dwordx4 v2, s[24:27], s56 offen offset:1024 nt lds
    v_perm_b32 v56, v69, v65, s63
    v_perm_b32 v57, v77, v73, s63
    v_perm_b32 v58, v85, v81, s63
    v_perm_b32 v59, v93, v89, s63
    v_perm_b32 v60, v69, v65, s64
    v_perm_b32 v61, v77, v73, s64
    v_perm_b32 v62, v85, v81, s64
    v_perm_b32 v63, v93, v89, s64
    s_nop 1
    v_mfma_f32_32x32x16_bf16 v[160:175], v[56:59], v[24:27], v[160:175]
    v_mfma_f32_32x32x16_bf16 v[176:191], v[60:63], v[24:27], v[176:191]
    s_waitcnt vmcnt(4)
    s_add_u32 m0, s60, 32
    s_nop 0
    buffer_load_dwordx4 v2, s[24:27], s56 offen offset:2048 nt lds
    v_perm_b32 v48, v70, v66, s63
    v_perm_b32 v49, v78, v74, s63
    v_perm_b32 v50, v86, v82, s63
    v_perm_b32 v51, v94, v90, s63
    v_perm_b32 v52, v70, v66, s64
    v_perm_b32 v53, v78, v74, s64
    v_perm_b32 v54, v86, v82, s64
    v_perm_b32 v55, v94, v90, s64
    s_nop 1
    v_mfma_f32_32x32x16_bf16 v[192:207], v[48:51], v[24:27], v[192:207]
    v_mfma_f32_32x32x16_bf16 v[208:223], v[52:55], v[24:27], v[208:223]
    s_waitcnt vmcnt(4)
    s_add_u32 m0, s60, 48
    s_nop 0
    buffer_load_dwordx4 v2, s[24:27], s56 offen offset:3072 nt lds
    v_perm_b32 v56, v71, v67, s63
    v_perm_b32 v57, v79, v75, s63
    v_perm_b32 v58, v87, v83, s63
    v_perm_b32 v59, v95, v91, s63
    v_perm_b32 v60, v71, v67, s64
    v_perm_b32 v61, v79, v75, s64
    v_perm_b32 v62, v87, v83, s64
    v_perm_b32 v63, v95, v91, s64
    s_nop 1
    v_mfma_f32_32x32x16_bf16 v[224:239], v[56:59], v[24:27], v[224:239]
    v_mfma_f32_32x32x16_bf16 v[240:255], v[60:63], v[24:27], v[240:255]
    s_waitcnt vmcnt(4)
    s_add_u32 m0, s60, 4160
    s_nop 0
    buffer_load_dwordx4 v2, s[24:27], s57 offen offset:0 nt lds
    v_perm_b32 v48, v100, v96, s63
    v_perm_b32 v49, v108, v104, s63
    v_perm_b32 v50, v116, v112, s63
    v_perm_b32 v51, v124, v120, s63
    v_perm_b32 v52, v100, v96, s64
    v_perm_b32 v53, v108, v104, s64
    v_perm_b32 v54, v116, v112, s64
    v_perm_b32 v55, v124, v120, s64
    s_nop 1
    v_mfma_f32_32x32x16_bf16 v[128:143], v[48:51], v[28:31], v[128:143]
    v_mfma_f32_32x32x16_bf16 v[144:159], v[52:55], v[28:31], v[144:159]
    s_waitcnt vmcnt(4)
    s_add_u32 m0, s60, 4176
    s_nop 0
    buffer_load_dwordx4 v2, s[24:27], s57 offen offset:1024 nt lds
    v_perm_b32 v56, v101, v97, s63
    v_perm_b32 v57, v109, v105, s63
    v_perm_b32 v58, v117, v113, s63
    v_perm_b32 v59, v125, v121, s63
    v_perm_b32 v60, v101, v97, s64
    v_perm_b32 v61, v109, v105, s64
    v_perm_b32 v62, v117, v113, s64
    v_perm_b32 v63, v125, v121, s64
    s_nop 1
    v_mfma_f32_32x32x16_bf16 v[160:175], v[56:59], v[28:31], v[160:175]
    v_mfma_f32_32x32x16_bf16 v[176:191], v[60:63], v[28:31], v[176:191]
    s_waitcnt vmcnt(4)
    s_add_u32 m0, s60, 4192
    s_nop 0
    buffer_load_dwordx4 v2, s[24:27], s57 offen offset:2048 nt lds
    v_perm_b32 v48, v102, v98, s63
    v_perm_b32 v49, v110, v106, s63
    v_perm_b32 v50, v118, v114, s63
    v_perm_b32 v51, v126, v122, s63
    v_perm_b32 v52, v102, v98, s64
    v_perm_b32 v53, v110, v106, s64
    v_perm_b32 v54, v118, v114, s64
    v_perm_b32 v55, v126, v122, s64
    s_nop 1
    v_mfma_f32_32x32x16_bf16 v[192:207], v[48:51], v[28:31], v[192:207]
    v_mfma_f32_32x32x16_bf16 v[208:223], v[52:55], v[28:31], v[208:223]
    s_waitcnt vmcnt(4)
    s_add_u32 m0, s60, 4208
    s_nop 0
    buffer_load_dwordx4 v2, s[24:27], s57 offen offset:3072 nt lds
    v_perm_b32 v56, v103, v99, s63
    v_perm_b32 v57, v111, v107, s63
    v_perm_b32 v58, v119, v115, s63
    v_perm_b32 v59, v127, v123, s63
    v_perm_b32 v60, v103, v99, s64
    v_perm_b32 v61, v111, v107, s64
    v_perm_b32 v62, v119, v115, s64
    v_perm_b32 v63, v127, v123, s64
    s_nop 1
    v_mfma_f32_32x32x16_bf16 v[224:239], v[56:59], v[28:31], v[224:239]
    v_mfma_f32_32x32x16_bf16 v[240:255], v[60:63], v[28:31], v[240:255]
    s_waitcnt vmcnt(4)
    s_add_u32 m0, s60, 8320
    s_nop 0
    buffer_load_dwordx4 v2, s[24:27], s58 offen offset:0 nt lds
    s_cmp_lg_u32 s61, s67
    s_cbranch_scc1 L_tree_loop_8
    ds_read_b128 a[64:67], v15 offset:0
    ds_read_b128 a[68:71], v15 offset:32
    ds_read_b128 a[72:75], v15 offset:64
    ds_read_b128 a[76:79], v15 offset:96
    ds_read_b128 a[80:83], v15 offset:128
    ds_read_b128 a[84:87], v15 offset:160
    ds_read_b128 a[88:91], v15 offset:192
    ds_read_b128 a[92:95], v15 offset:224
    v_lshlrev_b32 v19, 16, v19
    v_sub_f32 v19, 1.0, v19
    v_mul_f32 v19, 0xceabfb8f, v19
L_tree_loop_8:
    s_waitcnt vmcnt(4)
    s_add_u32 m0, s60, 8336
    s_nop 0
    buffer_load_dwordx4 v2, s[24:27], s58 offen offset:1024 nt lds
    s_cmp_lg_u32 s61, s67
    s_cbranch_scc1 L_tree_loop_9
    s_waitcnt lgkmcnt(0)
    ds_read_b128 a[96:99], v15 offset:256
    ds_read_b128 a[100:103], v15 offset:288
    ds_read_b128 a[104:107], v15 offset:320
    ds_read_b128 a[108:111], v15 offset:352
    ds_read_b128 a[112:115], v15 offset:384
    ds_read_b128 a[116:119], v15 offset:416
    ds_read_b128 a[120:123], v15 offset:448
    ds_read_b128 a[124:127], v15 offset:480
    v_mfma_f32_32x32x16_bf16 v[32:47], a[64:67], a[0:3], 0
    v_mfma_f32_32x32x16_bf16 v[32:47], a[68:71], a[4:7], v[32:47]
    v_mfma_f32_32x32x16_bf16 v[32:47], a[72:75], a[8:11], v[32:47]
    v_mfma_f32_32x32x16_bf16 v[32:47], a[76:79], a[12:15], v[32:47]
    v_mfma_f32_32x32x16_bf16 v[32:47], a[80:83], a[16:19], v[32:47]
    v_mfma_f32_32x32x16_bf16 v[32:47], a[84:87], a[20:23], v[32:47]
    v_mfma_f32_32x32x16_bf16 v[32:47], a[88:91], a[24:27], v[32:47]
    v_mfma_f32_32x32x16_bf16 v[32:47], a[92:95], a[28:31], v[32:47]
L_tree_loop_9:
    s_waitcnt vmcnt(4)
    s_add_u32 m0, s60, 8352
    s_nop 0
    buffer_load_dwordx4 v2, s[24:27], s58 offen offset:2048 nt lds
    s_cmp_lg_u32 s61, s67
    s_cbranch_scc1 L_tree_loop_10
    s_waitcnt lgkmcnt(0)
    v_mfma_f32_32x32x16_bf16 v[32:47], a[96:99], a[32:35], v[32:47]
    v_mfma_f32_32x32x16_bf16 v[32:47], a[100:103], a[36:39], v[32:47]
    v_mfma_f32_32x32x16_bf16 v[32:47], a[104:107], a[40:43], v[32:47]
    v_mfma_f32_32x32x16_bf16 v[32:47], a[108:111], a[44:47], v[32:47]
    v_mfma_f32_32x32x16_bf16 v[32:47], a[112:115], a[48:51], v[32:47]
    v_mfma_f32_32x32x16_bf16 v[32:47], a[116:119], a[52:55], v[32:47]
    v_mfma_f32_32x32x16_bf16 v[32:47], a[120:123], a[56:59], v[32:47]
    v_mfma_f32_32x32x16_bf16 v[32:47], a[124:127], a[60:63], v[32:47]
L_tree_loop_10:
    s_waitcnt vmcnt(4)
    s_add_u32 m0, s60, 8368
    s_nop 0
    buffer_load_dwordx4 v2, s[24:27], s58 offen offset:3072 nt lds
    s_cmp_lg_u32 s61, s67
    s_cbranch_scc1 L_tree_loop_11
    v_mov_b32 v48, 0
    v_mov_b32 v49, 0
    v_mov_b32 v50, 0
    v_mov_b32 v51, 0
    v_mov_b32 v52, 0
    v_mov_b32 v53, 0
    v_mov_b32 v54, 0
    v_mov_b32 v55, 0
    v_mov_b32 v56, 0
    v_mov_b32 v57, 0
    v_mov_b32 v58, 0
    v_mov_b32 v59, 0
    v_mov_b32 v60, 0
    v_mov_b32 v61, 0
    v_mov_b32 v62, 0
    v_mov_b32 v63, 0
    v_mov_b32 v25, 0
    v_mov_b32 v26, 0
    v_mov_b32 v27, 0
    s_nop 4
    v_fma_f32 v9, v32, s62, v19
    v_mov_b32 v10, v9
    v_mov_b32 v12, v9
    s_nop 1
    v_permlane32_swap_b32 v9, v10
    s_nop 1
    v_max3_f32 v8, v5, v9, v10
    v_sub_f32 v10, v5, v8
    v_sub_f32 v12, v12, v8
    v_exp_f32 v7, v10
    v_exp_f32 v12, v12
    v_cmp_gt_f32 vcc, v8, v5
    v_mov_b32 v5, v8
    v_fma_f32 v6, v6, v7, v12
    v_cvt_pk_bf16_f32 v24, v12, 0
    s_nop 1
L_tree_loop_11:
    s_waitcnt vmcnt(4)
    s_add_u32 m0, s60, 12480
    s_nop 0
    buffer_load_dwordx4 v2, s[24:27], s59 offen offset:0 nt lds
    s_cmp_lg_u32 s61, s67
    s_cbranch_scc1 L_tree_loop_12
    s_cbranch_vccz L_tskip_loop_0
    v_mul_f32 v128, v7, v128
    v_mul_f32 v129, v7, v129
    v_mul_f32 v130, v7, v130
    v_mul_f32 v131, v7, v131
    v_mul_f32 v132, v7, v132
    v_mul_f32 v133, v7, v133
    v_mul_f32 v134, v7, v134
    v_mul_f32 v135, v7, v135
    v_mul_f32 v136, v7, v136
    v_mul_f32 v137, v7, v137
    v_mul_f32 v138, v7, v138
    v_mul_f32 v139, v7, v139
    v_mul_f32 v140, v7, v140
    v_mul_f32 v141, v7, v141
    v_mul_f32 v142, v7, v142
    v_mul_f32 v143, v7, v143
    v_mul_f32 v144, v7, v144
    v_mul_f32 v145, v7, v145
    v_mul_f32 v146, v7, v146
    v_mul_f32 v147, v7, v147
    v_mul_f32 v148, v7, v148
    v_mul_f32 v149, v7, v149
    v_mul_f32 v150, v7, v150
    v_mul_f32 v151, v7, v151
    v_mul_f32 v152, v7, v152
    v_mul_f32 v153, v7, v153
    v_mul_f32 v154, v7, v154
    v_mul_f32 v155, v7, v155
    v_mul_f32 v156, v7, v156
    v_mul_f32 v157, v7, v157
    v_mul_f32 v158, v7, v158
    v_mul_f32 v159, v7, v159
    v_mul_f32 v160, v7, v160
    v_mul_f32 v161, v7, v161
    v_mul_f32 v162, v7, v162
    v_mul_f32 v163, v7, v163
    v_mul_f32 v164, v7, v164
    v_mul_f32 v165, v7, v165
    v_mul_f32 v166, v7, v166
    v_mul_f32 v167, v7, v167
    v_mul_f32 v168, v7, v168
    v_mul_f32 v169, v7, v169
    v_mul_f32 v170, v7, v170
    v_mul_f32 v171, v7, v171
    v_mul_f32 v172, v7, v172
    v_mul_f32 v173, v7, v173
    v_mul_f32 v174, v7, v174
    v_mul_f32 v175, v7, v175
    v_mul_f32 v176, v7, v176
    v_mul_f32 v177, v7, v177
    v_mul_f32 v178, v7, v178
    v_mul_f32 v179, v7, v179
    v_mul_f32 v180, v7, v180
    v_mul_f32 v181, v7, v181
    v_mul_f32 v182, v7, v182
    v_mul_f32 v183, v7, v183
    v_mul_f32 v184, v7, v184
    v_mul_f32 v185, v7, v185
    v_mul_f32 v186, v7, v186
    v_mul_f32 v187, v7, v187
    v_mul_f32 v188, v7, v188
    v_mul_f32 v189, v7, v189
    v_mul_f32 v190, v7, v190
    v_mul_f32 v191, v7, v191
L_tskip_loop_0:
L_tree_loop_12:
    s_waitcnt vmcnt(4)
    s_add_u32 m0, s60, 12496
    s_nop 0
    buffer_load_dwordx4 v2, s[24:27], s59 offen offset:1024 nt lds
    s_cmp_lg_u32 s61, s67
    s_cbranch_scc1 L_tree_loop_13
    s_cbranch_vccz L_tskip_loop_1
    v_mul_f32 v192, v7, v192
    v_mul_f32 v193, v7, v193
    v_mul_f32 v194, v7, v194
    v_mul_f32 v195, v7, v195
    v_mul_f32 v196, v7, v196
    v_mul_f32 v197, v7, v197
    v_mul_f32 v198, v7, v198
    v_mul_f32 v199, v7, v199
    v_mul_f32 v200, v7, v200
    v_mul_f32 v201, v7, v201
    v_mul_f32 v202, v7, v202
    v_mul_f32 v203, v7, v203
    v_mul_f32 v204, v7, v204
    v_mul_f32 v205, v7, v205
    v_mul_f32 v206, v7, v206
    v_mul_f32 v207, v7, v207
    v_mul_f32 v208, v7, v208
    v_mul_f32 v209, v7, v209
    v_mul_f32 v210, v7, v210
    v_mul_f32 v211, v7, v211
    v_mul_f32 v212, v7, v212
    v_mul_f32 v213, v7, v213
    v_mul_f32 v214, v7, v214
    v_mul_f32 v215, v7, v215
    v_mul_f32 v216, v7, v216
    v_mul_f32 v217, v7, v217
    v_mul_f32 v218, v7, v218
    v_mul_f32 v219, v7, v219
    v_mul_f32 v220, v7, v220
    v_mul_f32 v221, v7, v221
    v_mul_f32 v222, v7, v222
    v_mul_f32 v223, v7, v223
    v_mul_f32 v224, v7, v224
    v_mul_f32 v225, v7, v225
    v_mul_f32 v226, v7, v226
    v_mul_f32 v227, v7, v227
    v_mul_f32 v228, v7, v228
    v_mul_f32 v229, v7, v229
    v_mul_f32 v230, v7, v230
    v_mul_f32 v231, v7, v231
    v_mul_f32 v232, v7, v232
    v_mul_f32 v233, v7, v233
    v_mul_f32 v234, v7, v234
    v_mul_f32 v235, v7, v235
    v_mul_f32 v236, v7, v236
    v_mul_f32 v237, v7, v237
    v_mul_f32 v238, v7, v238
    v_mul_f32 v239, v7, v239
    v_mul_f32 v240, v7, v240
    v_mul_f32 v241, v7, v241
    v_mul_f32 v242, v7, v242
    v_mul_f32 v243, v7, v243
    v_mul_f32 v244, v7, v244
    v_mul_f32 v245, v7, v245
    v_mul_f32 v246, v7, v246
    v_mul_f32 v247, v7, v247
    v_mul_f32 v248, v7, v248
    v_mul_f32 v249, v7, v249
    v_mul_f32 v250, v7, v250
    v_mul_f32 v251, v7, v251
    v_mul_f32 v252, v7, v252
    v_mul_f32 v253, v7, v253
    v_mul_f32 v254, v7, v254
    v_mul_f32 v255, v7, v255
L_tskip_loop_1:
L_tree_loop_13:
    s_waitcnt vmcnt(4)
    s_add_u32 m0, s60, 12512
    s_nop 0
    buffer_load_dwordx4 v2, s[24:27], s59 offen offset:2048 nt lds
    s_cmp_lg_u32 s61, s67
    s_cbranch_scc1 L_tree_loop_14
    v_and_b32 v48, 0xffff, v20
    v_lshrrev_b32 v52, 16, v20
    v_and_b32 v56, 0xffff, v21
    v_lshrrev_b32 v60, 16, v21
    s_nop 1
    v_mfma_f32_32x32x16_bf16 v[128:143], v[48:51], v[24:27], v[128:143]
    v_mfma_f32_32x32x16_bf16 v[144:159], v[52:55], v[24:27], v[144:159]
    v_mfma_f32_32x32x16_bf16 v[160:175], v[56:59], v[24:27], v[160:175]
    v_mfma_f32_32x32x16_bf16 v[176:191], v[60:63], v[24:27], v[176:191]
L_tree_loop_14:
    s_waitcnt vmcnt(4)
    s_add_u32 m0, s60, 12528
    s_nop 0
    buffer_load_dwordx4 v2, s[24:27], s59 offen offset:3072 nt lds
    s_cmp_lg_u32 s61, s67
    s_cbranch_scc1 L_tree_loop_15
    v_and_b32 v48, 0xffff, v22
    v_lshrrev_b32 v52, 16, v22
    v_and_b32 v56, 0xffff, v23
    v_lshrrev_b32 v60, 16, v23
    s_nop 1
    v_mfma_f32_32x32x16_bf16 v[192:207], v[48:51], v[24:27], v[192:207]
    v_mfma_f32_32x32x16_bf16 v[208:223], v[52:55], v[24:27], v[208:223]
    v_mfma_f32_32x32x16_bf16 v[224:239], v[56:59], v[24:27], v[224:239]
    v_mfma_f32_32x32x16_bf16 v[240:255], v[60:63], v[24:27], v[240:255]
L_tree_loop_15:
    s_cmp_lg_u32 s61, 15
    s_cbranch_scc1 L_tp_loop
    s_cmp_lg_u32 s22, 0
    s_cbranch_scc1 L_tp_loop
    s_waitcnt vmcnt(4)
    v_lshrrev_b32 v13, s79, v13
    v_and_b32 v13, 0xffff, v13
    v_add_u32 v13, 1, v13
    v_mov_b32 v12, 101376
    s_mov_b64 exec, 1
    ds_write_b32 v12, v13
    s_mov_b64 exec, -1
L_tp_loop:
    s_cmp_eq_u32 s61, 14
    s_cbranch_scc1 L_final
    s_branch L_loop
L_final:
    s_waitcnt vmcnt(4)
    buffer_load_dwordx4 v[64:67], v2, s[28:31], s56 offen offset:0 nt
    s_add_u32 s36, s56, 131072
    s_add_u32 s37, s57, 131072
    s_add_u32 s38, s58, 131072
    s_add_u32 s39, s59, 131072
    s_add_u32 s52, s20, s76
    s_addc_u32 s53, s21, 0
    s_mov_b32 s54, 131072
    s_mov_b32 s55, 0x20000
    s_add_u32 s48, s16, s73
    s_addc_u32 s49, s17, 0
    s_mov_b32 s50, 16384
    s_mov_b32 s51, 0x20000
    v_lshlrev_b32 v14, 3, v1
    v_add_u32 v21, 4096, v2
    s_lshl_b32 s79, s22, 2
    s_add_u32 s79, s79, 36864
    v_mov_b32 v20, s79
    s_waitcnt vmcnt(4)
    buffer_load_dwordx4 v[68:71], v2, s[28:31], s56 offen offset:1024 nt
    s_lshl_b32 s79, s22, 9
    s_add_u32 s79, s79, 99328
    v_add_u32 v15, s79, v14
    v_add_u32 v22, 99328, v14
    v_and_b32 v9, 3, v1
    v_lshlrev_b32 v23, 4, v9
    v_bfe_u32 v9, v1, 3, 2
    v_lshl_add_u32 v23, v9, 2, v23
    v_bfe_u32 v9, v1, 2, 1
    v_lshl_add_u32 v23, v9, 6, v23
    v_lshrrev_b32 v9, 5, v1
    v_lshl_add_u32 v23, v9, 9, v23
    s_lshl_b32 s79, s22, 7
    s_add_u32 s79, s79, 102400
    v_add_u32 v23, s79, v23
    s_waitcnt vmcnt(4)
    buffer_load_dwordx4 v[72:75], v2, s[28:31], s56 offen offset:2048 nt
    s_waitcnt vmcnt(4)
    buffer_load_dwordx4 v[76:79], v2, s[28:31], s56 offen offset:3072 nt
    s_waitcnt vmcnt(4)
    buffer_load_dwordx4 v[80:83], v2, s[28:31], s57 offen offset:0 nt
    ds_read_b128 a[64:67], v4 offset:0
    ds_read_b128 a[68:71], v4 offset:32
    ds_read_b128 a[72:75], v4 offset:64
    ds_read_b128 a[76:79], v4 offset:96
    ds_read_b128 a[80:83], v4 offset:128
    ds_read_b128 a[84:87], v4 offset:160
    ds_read_b128 a[88:91], v4 offset:192
    ds_read_b128 a[92:95], v4 offset:224
    s_waitcnt vmcnt(4)
    buffer_load_dwordx4 v[84:87], v2, s[28:31], s57 offen offset:1024 nt
    s_waitcnt lgkmcnt(0)
    ds_read_b128 a[96:99], v4 offset:256
    ds_read_b128 a[100:103], v4 offset:288
    ds_read_b128 a[104:107], v4 offset:320
    ds_read_b128 a[108:111], v4 offset:352
    ds_read_b128 a[112:115], v4 offset:384
    ds_read_b128 a[116:119], v4 offset:416
    ds_read_b128 a[120:123], v4 offset:448
    ds_read_b128 a[124:127], v4 offset:480
    v_mfma_f32_32x32x16_bf16 v[32:47], a[64:67], a[0:3], 0
    v_mfma_f32_32x32x16_bf16 v[32:47], a[68:71], a[4:7], v[32:47]
    v_mfma_f32_32x32x16_bf16 v[32:47], a[72:75], a[8:11], v[32:47]
    v_mfma_f32_32x32x16_bf16 v[32:47], a[76:79], a[12:15], v[32:47]
    s_waitcnt vmcnt(4)
    buffer_load_dwordx4 v[88:91], v2, s[28:31], s57 offen offset:2048 nt
    v_mfma_f32_32x32x16_bf16 v[32:47], a[80:83], a[16:19], v[32:47]
    v_mfma_f32_32x32x16_bf16 v[32:47], a[84:87], a[20:23], v[32:47]
    v_mfma_f32_32x32x16_bf16 v[32:47], a[88:91], a[24:27], v[32:47]
    v_mfma_f32_32x32x16_bf16 v[32:47], a[92:95], a[28:31], v[32:47]
    s_waitcnt vmcnt(4)
    buffer_load_dwordx4 v[92:95], v2, s[28:31], s57 offen offset:3072 nt
    s_waitcnt lgkmcnt(0)
    v_mfma_f32_32x32x16_bf16 v[32:47], a[96:99], a[32:35], v[32:47]
    v_mfma_f32_32x32x16_bf16 v[32:47], a[100:103], a[36:39], v[32:47]
    v_mfma_f32_32x32x16_bf16 v[32:47], a[104:107], a[40:43], v[32:47]
    v_mfma_f32_32x32x16_bf16 v[32:47], a[108:111], a[44:47], v[32:47]
    s_barrier
    s_cmp_lg_u32 s22, 0
    s_cbranch_scc1 L_tk_g
    s_lshr_b32 s78, s70, 1
    s_lshl_b32 s78, s78, 2
    s_and_b32 s79, s70, 1
    s_lshl_b32 s79, s79, 4
    s_lshl_b32 s80, 1, s79
    v_mov_b32 v12, s78
    v_mov_b32 v13, s80
    s_mov_b64 exec, 1
    global_atomic_add v13, v12, v13, s[18:19] sc0 sc1
    s_mov_b64 exec, -1
L_tk_g:
    s_waitcnt vmcnt(4)
    s_add_u32 m0, s60, 0
    s_nop 0
    buffer_load_dwordx4 v2, s[24:27], s36 offen offset:0 nt lds
    v_mfma_f32_32x32x16_bf16 v[32:47], a[112:115], a[48:51], v[32:47]
    v_mfma_f32_32x32x16_bf16 v[32:47], a[116:119], a[52:55], v[32:47]
    v_mfma_f32_32x32x16_bf16 v[32:47], a[120:123], a[56:59], v[32:47]
    v_mfma_f32_32x32x16_bf16 v[32:47], a[124:127], a[60:63], v[32:47]
    s_waitcnt vmcnt(4)
    s_add_u32 m0, s60, 16
    s_nop 0
    buffer_load_dwordx4 v2, s[24:27], s36 offen offset:1024 nt lds
    s_nop 11
    v_max3_f32 v9, v32, v33, v34
    v_max3_f32 v10, v35, v36, v37
    v_max3_f32 v9, v9, v38, v39
    v_max3_f32 v10, v10, v40, v41
    v_max3_f32 v9, v9, v42, v43
    v_max3_f32 v10, v10, v44, v45
    v_max3_f32 v9, v9, v46, v47
    v_max_f32 v9, v9, v10
    v_mov_b32 v10, v9
    s_nop 1
    v_permlane32_swap_b32 v9, v10
    s_nop 1
    v_max_f32 v9, v9, v10
    v_mul_f32 v9, s62, v9
    v_max_f32 v8, v5, v9
    v_sub_f32 v10, v5, v8
    v_exp_f32 v7, v10
    v_cmp_gt_f32 vcc, v8, v5
    v_mov_b32 v5, v8
    v_mul_f32 v6, v6, v7
    s_nop 1
    s_waitcnt vmcnt(4)
    s_add_u32 m0, s60, 32
    s_nop 0
    buffer_load_dwordx4 v2, s[24:27], s36 offen offset:2048 nt lds
    s_cbranch_vccz L_skip_g14_0
    v_mul_f32 v128, v7, v128
    v_mul_f32 v129, v7, v129
    v_mul_f32 v130, v7, v130
    v_mul_f32 v131, v7, v131
    v_mul_f32 v132, v7, v132
    v_mul_f32 v133, v7, v133
    v_mul_f32 v134, v7, v134
    v_mul_f32 v135, v7, v135
    v_mul_f32 v136, v7, v136
    v_mul_f32 v137, v7, v137
    v_mul_f32 v138, v7, v138
    v_mul_f32 v139, v7, v139
    v_mul_f32 v140, v7, v140
    v_mul_f32 v141, v7, v141
    v_mul_f32 v142, v7, v142
    v_mul_f32 v143, v7, v143
    v_mul_f32 v144, v7, v144
    v_mul_f32 v145, v7, v145
    v_mul_f32 v146, v7, v146
    v_mul_f32 v147, v7, v147
    v_mul_f32 v148, v7, v148
    v_mul_f32 v149, v7, v149
    v_mul_f32 v150, v7, v150
    v_mul_f32 v151, v7, v151
    v_mul_f32 v152, v7, v152
    v_mul_f32 v153, v7, v153
    v_mul_f32 v154, v7, v154
    v_mul_f32 v155, v7, v155
    v_mul_f32 v156, v7, v156
    v_mul_f32 v157, v7, v157
    v_mul_f32 v158, v7, v158
    v_mul_f32 v159, v7, v159
    v_mul_f32 v160, v7, v160
    v_mul_f32 v161, v7, v161
    v_mul_f32 v162, v7, v162
    v_mul_f32 v163, v7, v163
    v_mul_f32 v164, v7, v164
    v_mul_f32 v165, v7, v165
    v_mul_f32 v166, v7, v166
    v_mul_f32 v167, v7, v167
    v_mul_f32 v168, v7, v168
    v_mul_f32 v169, v7, v169
    v_mul_f32 v170, v7, v170
    v_mul_f32 v171, v7, v171
    v_mul_f32 v172, v7, v172
    v_mul_f32 v173, v7, v173
    v_mul_f32 v174, v7, v174
    v_mul_f32 v175, v7, v175
    v_mul_f32 v176, v7, v176
    v_mul_f32 v177, v7, v177
    v_mul_f32 v178, v7, v178
    v_mul_f32 v179, v7, v179
    v_mul_f32 v180, v7, v180
    v_mul_f32 v181, v7, v181
    v_mul_f32 v182, v7, v182
    v_mul_f32 v183, v7, v183
    v_mul_f32 v184, v7, v184
    v_mul_f32 v185, v7, v185
    v_mul_f32 v186, v7, v186
    v_mul_f32 v187, v7, v187
    v_mul_f32 v188, v7, v188
    v_mul_f32 v189, v7, v189
    v_mul_f32 v190, v7, v190
    v_mul_f32 v191, v7, v191
L_skip_g14_0:
    s_waitcnt vmcnt(4)
    s_add_u32 m0, s60, 48
    s_nop 0
    buffer_load_dwordx4 v2, s[24:27], s36 offen offset:3072 nt lds
    s_cbranch_vccz L_skip_g14_1
    v_mul_f32 v192, v7, v192
    v_mul_f32 v193, v7, v193
    v_mul_f32 v194, v7, v194
    v_mul_f32 v195, v7, v195
    v_mul_f32 v196, v7, v196
    v_mul_f32 v197, v7, v197
    v_mul_f32 v198, v7, v198
    v_mul_f32 v199, v7, v199
    v_mul_f32 v200, v7, v200
    v_mul_f32 v201, v7, v201
    v_mul_f32 v202, v7, v202
    v_mul_f32 v203, v7, v203
    v_mul_f32 v204, v7, v204
    v_mul_f32 v205, v7, v205
    v_mul_f32 v206, v7, v206
    v_mul_f32 v207, v7, v207
    v_mul_f32 v208, v7, v208
    v_mul_f32 v209, v7, v209
    v_mul_f32 v210, v7, v210
    v_mul_f32 v211, v7, v211
    v_mul_f32 v212, v7, v212
    v_mul_f32 v213, v7, v213
    v_mul_f32 v214, v7, v214
    v_mul_f32 v215, v7, v215
    v_mul_f32 v216, v7, v216
    v_mul_f32 v217, v7, v217
    v_mul_f32 v218, v7, v218
    v_mul_f32 v219, v7, v219
    v_mul_f32 v220, v7, v220
    v_mul_f32 v221, v7, v221
    v_mul_f32 v222, v7, v222
    v_mul_f32 v223, v7, v223
    v_mul_f32 v224, v7, v224
    v_mul_f32 v225, v7, v225
    v_mul_f32 v226, v7, v226
    v_mul_f32 v227, v7, v227
    v_mul_f32 v228, v7, v228
    v_mul_f32 v229, v7, v229
    v_mul_f32 v230, v7, v230
    v_mul_f32 v231, v7, v231
    v_mul_f32 v232, v7, v232
    v_mul_f32 v233, v7, v233
    v_mul_f32 v234, v7, v234
    v_mul_f32 v235, v7, v235
    v_mul_f32 v236, v7, v236
    v_mul_f32 v237, v7, v237
    v_mul_f32 v238, v7, v238
    v_mul_f32 v239, v7, v239
    v_mul_f32 v240, v7, v240
    v_mul_f32 v241, v7, v241
    v_mul_f32 v242, v7, v242
    v_mul_f32 v243, v7, v243
    v_mul_f32 v244, v7, v244
    v_mul_f32 v245, v7, v245
    v_mul_f32 v246, v7, v246
    v_mul_f32 v247, v7, v247
    v_mul_f32 v248, v7, v248
    v_mul_f32 v249, v7, v249
    v_mul_f32 v250, v7, v250
    v_mul_f32 v251, v7, v251
    v_mul_f32 v252, v7, v252
    v_mul_f32 v253, v7, v253
    v_mul_f32 v254, v7, v254
    v_mul_f32 v255, v7, v255
L_skip_g14_1:
    s_waitcnt vmcnt(4)
    s_add_u32 m0, s60, 4160
    s_nop 0
    buffer_load_dwordx4 v2, s[24:27], s37 offen offset:0 nt lds
    v_fma_f32 v32, v32, s62, -v5
    v_fma_f32 v33, v33, s62, -v5
    v_fma_f32 v34, v34, s62, -v5
    v_fma_f32 v35, v35, s62, -v5
    v_fma_f32 v36, v36, s62, -v5
    v_fma_f32 v37, v37, s62, -v5
    v_fma_f32 v38, v38, s62, -v5
    v_fma_f32 v39, v39, s62, -v5
    v_exp_f32 v32, v32
    v_exp_f32 v33, v33
    v_exp_f32 v34, v34
    v_exp_f32 v35, v35
    v_exp_f32 v36, v36
    v_exp_f32 v37, v37
    v_exp_f32 v38, v38
    v_exp_f32 v39, v39
    s_nop 0
    v_cvt_pk_bf16_f32 v24, v32, v33
    v_cvt_pk_bf16_f32 v25, v34, v35
    v_cvt_pk_bf16_f32 v26, v36, v37
    v_cvt_pk_bf16_f32 v27, v38, v39
    v_add_f32 v9, v32, v33
    v_add_f32 v10, v34, v35
    v_add_f32 v9, v9, v36
    v_add_f32 v10, v10, v37
    v_add_f32 v9, v9, v38
    v_add_f32 v10, v10, v39
    v_add_f32 v9, v9, v10
    v_add_f32 v6, v6, v9
    s_waitcnt vmcnt(4)
    s_add_u32 m0, s60, 4176
    s_nop 0
    buffer_load_dwordx4 v2, s[24:27], s37 offen offset:1024 nt lds
    v_fma_f32 v40, v40, s62, -v5
    v_fma_f32 v41, v41, s62, -v5
    v_fma_f32 v42, v42, s62, -v5
    v_fma_f32 v43, v43, s62, -v5
    v_fma_f32 v44, v44, s62, -v5
    v_fma_f32 v45, v45, s62, -v5
    v_fma_f32 v46, v46, s62, -v5
    v_fma_f32 v47, v47, s62, -v5
    v_exp_f32 v40, v40
    v_exp_f32 v41, v41
    v_exp_f32 v42, v42
    v_exp_f32 v43, v43
    v_exp_f32 v44, v44
    v_exp_f32 v45, v45
    v_exp_f32 v46, v46
    v_exp_f32 v47, v47
    s_nop 0
    v_cvt_pk_bf16_f32 v28, v40, v41
    v_cvt_pk_bf16_f32 v29, v42, v43
    v_cvt_pk_bf16_f32 v30, v44, v45
    v_cvt_pk_bf16_f32 v31, v46, v47
    v_add_f32 v9, v40, v41
    v_add_f32 v10, v42, v43
    v_add_f32 v9, v9, v44
    v_add_f32 v10, v10, v45
    v_add_f32 v9, v9, v46
    v_add_f32 v10, v10, v47
    v_add_f32 v9, v9, v10
    v_add_f32 v6, v6, v9
    s_waitcnt vmcnt(4)
    s_add_u32 m0, s60, 4192
    s_nop 0
    buffer_load_dwordx4 v2, s[24:27], s37 offen offset:2048 nt lds
    v_perm_b32 v48, v68, v64, s63
    v_perm_b32 v49, v76, v72, s63
    v_perm_b32 v50, v84, v80, s63
    v_perm_b32 v51, v92, v88, s63
    v_perm_b32 v52, v68, v64, s64
    v_perm_b32 v53, v76, v72, s64
    v_perm_b32 v54, v84, v80, s64
    v_perm_b32 v55, v92, v88, s64
    s_nop 1
    v_mfma_f32_32x32x16_bf16 v[128:143], v[48:51], v[24:27], v[128:143]
    v_mfma_f32_32x32x16_bf16 v[144:159], v[52:55], v[24:27], v[144:159]
    s_waitcnt vmcnt(4)
    s_add_u32 m0, s60, 4208
    s_nop 0
    buffer_load_dwordx4 v2, s[24:27], s37 offen offset:3072 nt lds
    v_perm_b32 v56, v69, v65, s63
    v_perm_b32 v57, v77, v73, s63
    v_perm_b32 v58, v85, v81, s63
    v_perm_b32 v59, v93, v89, s63
    v_perm_b32 v60, v69, v65, s64
    v_perm_b32 v61, v77, v73, s64
    v_perm_b32 v62, v85, v81, s64
    v_perm_b32 v63, v93, v89, s64
    s_nop 1
    v_mfma_f32_32x32x16_bf16 v[160:175], v[56:59], v[24:27], v[160:175]
    v_mfma_f32_32x32x16_bf16 v[176:191], v[60:63], v[24:27], v[176:191]
    s_waitcnt vmcnt(4)
    s_add_u32 m0, s60, 8320
    s_nop 0
    buffer_load_dwordx4 v2, s[24:27], s38 offen offset:0 nt lds
    v_perm_b32 v48, v70, v66, s63
    v_perm_b32 v49, v78, v74, s63
    v_perm_b32 v50, v86, v82, s63
    v_perm_b32 v51, v94, v90, s63
    v_perm_b32 v52, v70, v66, s64
    v_perm_b32 v53, v78, v74, s64
    v_perm_b32 v54, v86, v82, s64
    v_perm_b32 v55, v94, v90, s64
    s_nop 1
    v_mfma_f32_32x32x16_bf16 v[192:207], v[48:51], v[24:27], v[192:207]
    v_mfma_f32_32x32x16_bf16 v[208:223], v[52:55], v[24:27], v[208:223]
    s_waitcnt vmcnt(4)
    s_add_u32 m0, s60, 8336
    s_nop 0
    buffer_load_dwordx4 v2, s[24:27], s38 offen offset:1024 nt lds
    v_perm_b32 v56, v71, v67, s63
    v_perm_b32 v57, v79, v75, s63
    v_perm_b32 v58, v87, v83, s63
    v_perm_b32 v59, v95, v91, s63
    v_perm_b32 v60, v71, v67, s64
    v_perm_b32 v61, v79, v75, s64
    v_perm_b32 v62, v87, v83, s64
    v_perm_b32 v63, v95, v91, s64
    s_nop 1
    v_mfma_f32_32x32x16_bf16 v[224:239], v[56:59], v[24:27], v[224:239]
    v_mfma_f32_32x32x16_bf16 v[240:255], v[60:63], v[24:27], v[240:255]
    s_waitcnt vmcnt(4)
    s_add_u32 m0, s60, 8352
    s_nop 0
    buffer_load_dwordx4 v2, s[24:27], s38 offen offset:2048 nt lds
    s_waitcnt vmcnt(4)
    s_add_u32 m0, s60, 8368
    s_nop 0
    buffer_load_dwordx4 v2, s[24:27], s38 offen offset:3072 nt lds
    s_waitcnt vmcnt(4)
    s_add_u32 m0, s60, 12480
    s_nop 0
    buffer_load_dwordx4 v2, s[24:27], s39 offen offset:0 nt lds
    s_waitcnt vmcnt(4)
    s_add_u32 m0, s60, 12496
    s_nop 0
    buffer_load_dwordx4 v2, s[24:27], s39 offen offset:1024 nt lds
    s_waitcnt vmcnt(4)
    s_add_u32 m0, s60, 12512
    s_nop 0
    buffer_load_dwordx4 v2, s[24:27], s39 offen offset:2048 nt lds
    s_waitcnt vmcnt(4)
    s_add_u32 m0, s60, 12528
    s_nop 0
    buffer_load_dwordx4 v2, s[24:27], s39 offen offset:3072 nt lds
    s_cmp_lg_u32 s22, 0
    s_cbranch_scc1 L_tp_g
    s_waitcnt vmcnt(4)
    v_lshrrev_b32 v13, s79, v13
    v_and_b32 v13, 0xffff, v13
    v_add_u32 v13, 1, v13
    v_mov_b32 v12, 101376
    s_mov_b64 exec, 1
    ds_write_b32 v12, v13
    s_mov_b64 exec, -1
L_tp_g:
    s_waitcnt vmcnt(4)
    buffer_load_dwordx4 v[96:99], v2, s[28:31], s58 offen offset:0 nt
    s_waitcnt vmcnt(4)
    buffer_load_dwordx4 v[100:103], v2, s[28:31], s58 offen offset:1024 nt
    s_lshl_b32 s78, s22, 13
    s_add_u32 s78, s78, 102400
    s_waitcnt vmcnt(4)
    buffer_load_dwordx4 v[104:107], v2, s[28:31], s58 offen offset:2048 nt
    s_waitcnt vmcnt(4)
    buffer_load_dwordx4 v[108:111], v2, s[28:31], s58 offen offset:3072 nt
    s_waitcnt vmcnt(4)
    buffer_load_dwordx4 v[112:115], v2, s[28:31], s59 offen offset:0 nt
    ds_read_b128 a[64:67], v4 offset:0
    ds_read_b128 a[68:71], v4 offset:32
    ds_read_b128 a[72:75], v4 offset:64
    ds_read_b128 a[76:79], v4 offset:96
    ds_read_b128 a[80:83], v4 offset:128
    ds_read_b128 a[84:87], v4 offset:160
    ds_read_b128 a[88:91], v4 offset:192
    ds_read_b128 a[92:95], v4 offset:224
    s_waitcnt vmcnt(4)
    buffer_load_dwordx4 v[116:119], v2, s[28:31], s59 offen offset:1024 nt
    s_waitcnt lgkmcnt(0)
    ds_read_b128 a[96:99], v4 offset:256
    ds_read_b128 a[100:103], v4 offset:288
    ds_read_b128 a[104:107], v4 offset:320
    ds_read_b128 a[108:111], v4 offset:352
    ds_read_b128 a[112:115], v4 offset:384
    ds_read_b128 a[116:119], v4 offset:416
    ds_read_b128 a[120:123], v4 offset:448
    ds_read_b128 a[124:127], v4 offset:480
    v_mfma_f32_32x32x16_bf16 v[32:47], a[64:67], a[0:3], 0
    v_mfma_f32_32x32x16_bf16 v[32:47], a[68:71], a[4:7], v[32:47]
    v_mfma_f32_32x32x16_bf16 v[32:47], a[72:75], a[8:11], v[32:47]
    v_mfma_f32_32x32x16_bf16 v[32:47], a[76:79], a[12:15], v[32:47]
    s_waitcnt vmcnt(4)
    buffer_load_dwordx4 v[120:123], v2, s[28:31], s59 offen offset:2048 nt
    v_mfma_f32_32x32x16_bf16 v[32:47], a[80:83], a[16:19], v[32:47]
    v_mfma_f32_32x32x16_bf16 v[32:47], a[84:87], a[20:23], v[32:47]
    v_mfma_f32_32x32x16_bf16 v[32:47], a[88:91], a[24:27], v[32:47]
    v_mfma_f32_32x32x16_bf16 v[32:47], a[92:95], a[28:31], v[32:47]
    s_waitcnt vmcnt(4)
    buffer_load_dwordx4 v[124:127], v2, s[28:31], s59 offen offset:3072 nt
    s_waitcnt lgkmcnt(0)
    v_mfma_f32_32x32x16_bf16 v[32:47], a[96:99], a[32:35], v[32:47]
    v_mfma_f32_32x32x16_bf16 v[32:47], a[100:103], a[36:39], v[32:47]
    v_mfma_f32_32x32x16_bf16 v[32:47], a[104:107], a[40:43], v[32:47]
    v_mfma_f32_32x32x16_bf16 v[32:47], a[108:111], a[44:47], v[32:47]
    s_waitcnt vmcnt(4)
    buffer_load_dwordx4 v[64:67], v2, s[28:31], s36 offen offset:0 nt
    v_mfma_f32_32x32x16_bf16 v[32:47], a[112:115], a[48:51], v[32:47]
    v_mfma_f32_32x32x16_bf16 v[32:47], a[116:119], a[52:55], v[32:47]
    v_mfma_f32_32x32x16_bf16 v[32:47], a[120:123], a[56:59], v[32:47]
    v_mfma_f32_32x32x16_bf16 v[32:47], a[124:127], a[60:63], v[32:47]
    s_waitcnt vmcnt(4)
    buffer_load_dwordx4 v[68:71], v2, s[28:31], s36 offen offset:1024 nt
    s_nop 11
    v_max3_f32 v9, v32, v33, v34
    v_max3_f32 v10, v35, v36, v37
    v_max3_f32 v9, v9, v38, v39
    v_max3_f32 v10, v10, v40, v41
    v_max3_f32 v9, v9, v42, v43
    v_max3_f32 v10, v10, v44, v45
    v_max3_f32 v9, v9, v46, v47
    v_max_f32 v9, v9, v10
    v_mov_b32 v10, v9
    s_nop 1
    v_permlane32_swap_b32 v9, v10
    s_nop 1
    v_max_f32 v9, v9, v10
    v_mul_f32 v9, s62, v9
    v_max_f32 v9, v5, v9
    ds_write_b32 v15, v9
    s_waitcnt lgkmcnt(0)
    s_barrier
    ds_read_b32 v24, v22 offset:0
    ds_read_b32 v25, v22 offset:512
    ds_read_b32 v26, v22 offset:1024
    ds_read_b32 v27, v22 offset:1536
    v_mov_b32 v12, 101376
    ds_read_b32 v13, v12
    s_waitcnt vmcnt(4)
    buffer_load_dwordx4 v[72:75], v2, s[28:31], s36 offen offset:2048 nt
    s_waitcnt lgkmcnt(0)
    v_max3_f32 v9, v24, v25, v26
    v_readfirstlane_b32 s82, v13
    v_max_f32 v8, v9, v27
    v_sub_f32 v10, v5, v8
    v_exp_f32 v7, v10
    v_cmp_gt_f32 vcc, v8, v5
    v_mov_b32 v5, v8
    v_mul_f32 v6, v6, v7
    buffer_load_dword v19, v20, s[52:55], s66 offen sc1
    s_nop 1
    s_waitcnt vmcnt(4)
    buffer_load_dwordx4 v[76:79], v2, s[28:31], s36 offen offset:3072 nt
    v_fma_f32 v32, v32, s62, -v5
    v_fma_f32 v33, v33, s62, -v5
    v_fma_f32 v34, v34, s62, -v5
    v_fma_f32 v35, v35, s62, -v5
    v_fma_f32 v36, v36, s62, -v5
    v_fma_f32 v37, v37, s62, -v5
    v_fma_f32 v38, v38, s62, -v5
    v_fma_f32 v39, v39, s62, -v5
    v_exp_f32 v32, v32
    v_exp_f32 v33, v33
    v_exp_f32 v34, v34
    v_exp_f32 v35, v35
    v_exp_f32 v36, v36
    v_exp_f32 v37, v37
    v_exp_f32 v38, v38
    v_exp_f32 v39, v39
    s_nop 0
    v_cvt_pk_bf16_f32 v24, v32, v33
    v_cvt_pk_bf16_f32 v25, v34, v35
    v_cvt_pk_bf16_f32 v26, v36, v37
    v_cvt_pk_bf16_f32 v27, v38, v39
    v_add_f32 v9, v32, v33
    v_add_f32 v10, v34, v35
    v_add_f32 v9, v9, v36
    v_add_f32 v10, v10, v37
    v_add_f32 v9, v9, v38
    v_add_f32 v10, v10, v39
    v_add_f32 v9, v9, v10
    v_add_f32 v6, v6, v9
    s_waitcnt vmcnt(4)
    buffer_load_dwordx4 v[80:83], v2, s[28:31], s37 offen offset:0 nt
    v_fma_f32 v40, v40, s62, -v5
    v_fma_f32 v41, v41, s62, -v5
    v_fma_f32 v42, v42, s62, -v5
    v_fma_f32 v43, v43, s62, -v5
    v_fma_f32 v44, v44, s62, -v5
    v_fma_f32 v45, v45, s62, -v5
    v_fma_f32 v46, v46, s62, -v5
    v_fma_f32 v47, v47, s62, -v5
    v_exp_f32 v40, v40
    v_exp_f32 v41, v41
    v_exp_f32 v42, v42
    v_exp_f32 v43, v43
    v_exp_f32 v44, v44
    v_exp_f32 v45, v45
    v_exp_f32 v46, v46
    v_exp_f32 v47, v47
    s_nop 0
    v_cvt_pk_bf16_f32 v32, v40, v41
    v_cvt_pk_bf16_f32 v33, v42, v43
    v_cvt_pk_bf16_f32 v34, v44, v45
    v_cvt_pk_bf16_f32 v35, v46, v47
    v_add_f32 v9, v40, v41
    v_add_f32 v10, v42, v43
    v_add_f32 v9, v9, v44
    v_add_f32 v10, v10, v45
    v_add_f32 v9, v9, v46
    v_add_f32 v10, v10, v47
    v_add_f32 v9, v9, v10
    v_add_f32 v6, v6, v9
    s_lshl_b32 s79, s22, 10
    s_add_u32 s79, s79, 135168
    v_add_u32 v12, s79, v2
    ds_write_b128 v12, v[32:35]
    v_mov_b32 v11, v6
    v_mov_b32 v9, v6
    s_nop 1
    v_permlane32_swap_b32 v11, v9
    s_nop 1
    v_add_f32 v11, v11, v9
    ds_write_b32 v15, v11 offset:4
    s_waitcnt vmcnt(4)
    buffer_load_dwordx4 v[84:87], v2, s[28:31], s37 offen offset:1024 nt
    v_perm_b32 v48, v100, v96, s63
    v_perm_b32 v49, v108, v104, s63
    v_perm_b32 v50, v116, v112, s63
    v_perm_b32 v51, v124, v120, s63
    v_perm_b32 v52, v100, v96, s64
    v_perm_b32 v53, v108, v104, s64
    v_perm_b32 v54, v116, v112, s64
    v_perm_b32 v55, v124, v120, s64
    s_nop 1
    v_mfma_f32_32x32x16_bf16 v[128:143], v[48:51], v[28:31], v[128:143]
    v_mfma_f32_32x32x16_bf16 v[144:159], v[52:55], v[28:31], v[144:159]
    s_waitcnt vmcnt(4)
    buffer_load_dwordx4 v[88:91], v2, s[28:31], s37 offen offset:2048 nt
    v_perm_b32 v56, v101, v97, s63
    v_perm_b32 v57, v109, v105, s63
    v_perm_b32 v58, v117, v113, s63
    v_perm_b32 v59, v125, v121, s63
    v_perm_b32 v60, v101, v97, s64
    v_perm_b32 v61, v109, v105, s64
    v_perm_b32 v62, v117, v113, s64
    v_perm_b32 v63, v125, v121, s64
    s_nop 1
    v_mfma_f32_32x32x16_bf16 v[160:175], v[56:59], v[28:31], v[160:175]
    v_mfma_f32_32x32x16_bf16 v[176:191], v[60:63], v[28:31], v[176:191]
    s_waitcnt vmcnt(4)
    buffer_load_dwordx4 v[92:95], v2, s[28:31], s37 offen offset:3072 nt
    v_perm_b32 v48, v102, v98, s63
    v_perm_b32 v49, v110, v106, s63
    v_perm_b32 v50, v118, v114, s63
    v_perm_b32 v51, v126, v122, s63
    v_perm_b32 v52, v102, v98, s64
    v_perm_b32 v53, v110, v106, s64
    v_perm_b32 v54, v118, v114, s64
    v_perm_b32 v55, v126, v122, s64
    s_nop 1
    v_mfma_f32_32x32x16_bf16 v[192:207], v[48:51], v[28:31], v[192:207]
    v_mfma_f32_32x32x16_bf16 v[208:223], v[52:55], v[28:31], v[208:223]
    s_waitcnt vmcnt(4)
    s_add_u32 m0, s78, 0
    s_nop 0
    buffer_load_dwordx4 v2, s[28:31], s38 offen offset:0 nt lds
    v_perm_b32 v56, v103, v99, s63
    v_perm_b32 v57, v111, v107, s63
    v_perm_b32 v58, v119, v115, s63
    v_perm_b32 v59, v127, v123, s63
    v_perm_b32 v60, v103, v99, s64
    v_perm_b32 v61, v111, v107, s64
    v_perm_b32 v62, v119, v115, s64
    v_perm_b32 v63, v127, v123, s64
    s_nop 1
    v_mfma_f32_32x32x16_bf16 v[224:239], v[56:59], v[28:31], v[224:239]
    v_mfma_f32_32x32x16_bf16 v[240:255], v[60:63], v[28:31], v[240:255]
    s_waitcnt vmcnt(4)
    s_add_u32 m0, s78, 0
    s_nop 0
    buffer_load_dwordx4 v2, s[28:31], s38 offen offset:1024 nt lds
    s_nop 7
    s_cbranch_vccz L_skip_final_0
    v_mul_f32 v128, v7, v128
    v_mul_f32 v129, v7, v129
    v_mul_f32 v130, v7, v130
    v_mul_f32 v131, v7, v131
    v_mul_f32 v132, v7, v132
    v_mul_f32 v133, v7, v133
    v_mul_f32 v134, v7, v134
    v_mul_f32 v135, v7, v135
    v_mul_f32 v136, v7, v136
    v_mul_f32 v137, v7, v137
    v_mul_f32 v138, v7, v138
    v_mul_f32 v139, v7, v139
    v_mul_f32 v140, v7, v140
    v_mul_f32 v141, v7, v141
    v_mul_f32 v142, v7, v142
    v_mul_f32 v143, v7, v143
    v_mul_f32 v144, v7, v144
    v_mul_f32 v145, v7, v145
    v_mul_f32 v146, v7, v146
    v_mul_f32 v147, v7, v147
    v_mul_f32 v148, v7, v148
    v_mul_f32 v149, v7, v149
    v_mul_f32 v150, v7, v150
    v_mul_f32 v151, v7, v151
    v_mul_f32 v152, v7, v152
    v_mul_f32 v153, v7, v153
    v_mul_f32 v154, v7, v154
    v_mul_f32 v155, v7, v155
    v_mul_f32 v156, v7, v156
    v_mul_f32 v157, v7, v157
    v_mul_f32 v158, v7, v158
    v_mul_f32 v159, v7, v159
    v_mul_f32 v160, v7, v160
    v_mul_f32 v161, v7, v161
    v_mul_f32 v162, v7, v162
    v_mul_f32 v163, v7, v163
    v_mul_f32 v164, v7, v164
    v_mul_f32 v165, v7, v165
    v_mul_f32 v166, v7, v166
    v_mul_f32 v167, v7, v167
    v_mul_f32 v168, v7, v168
    v_mul_f32 v169, v7, v169
    v_mul_f32 v170, v7, v170
    v_mul_f32 v171, v7, v171
    v_mul_f32 v172, v7, v172
    v_mul_f32 v173, v7, v173
    v_mul_f32 v174, v7, v174
    v_mul_f32 v175, v7, v175
    v_mul_f32 v176, v7, v176
    v_mul_f32 v177, v7, v177
    v_mul_f32 v178, v7, v178
    v_mul_f32 v179, v7, v179
    v_mul_f32 v180, v7, v180
    v_mul_f32 v181, v7, v181
    v_mul_f32 v182, v7, v182
    v_mul_f32 v183, v7, v183
    v_mul_f32 v184, v7, v184
    v_mul_f32 v185, v7, v185
    v_mul_f32 v186, v7, v186
    v_mul_f32 v187, v7, v187
    v_mul_f32 v188, v7, v188
    v_mul_f32 v189, v7, v189
    v_mul_f32 v190, v7, v190
    v_mul_f32 v191, v7, v191
L_skip_final_0:
    s_waitcnt vmcnt(4)
    s_add_u32 m0, s78, 0
    s_nop 0
    buffer_load_dwordx4 v2, s[28:31], s38 offen offset:2048 nt lds
    s_cbranch_vccz L_skip_final_1
    v_mul_f32 v192, v7, v192
    v_mul_f32 v193, v7, v193
    v_mul_f32 v194, v7, v194
    v_mul_f32 v195, v7, v195
    v_mul_f32 v196, v7, v196
    v_mul_f32 v197, v7, v197
    v_mul_f32 v198, v7, v198
    v_mul_f32 v199, v7, v199
    v_mul_f32 v200, v7, v200
    v_mul_f32 v201, v7, v201
    v_mul_f32 v202, v7, v202
    v_mul_f32 v203, v7, v203
    v_mul_f32 v204, v7, v204
    v_mul_f32 v205, v7, v205
    v_mul_f32 v206, v7, v206
    v_mul_f32 v207, v7, v207
    v_mul_f32 v208, v7, v208
    v_mul_f32 v209, v7, v209
    v_mul_f32 v210, v7, v210
    v_mul_f32 v211, v7, v211
    v_mul_f32 v212, v7, v212
    v_mul_f32 v213, v7, v213
    v_mul_f32 v214, v7, v214
    v_mul_f32 v215, v7, v215
    v_mul_f32 v216, v7, v216
    v_mul_f32 v217, v7, v217
    v_mul_f32 v218, v7, v218
    v_mul_f32 v219, v7, v219
    v_mul_f32 v220, v7, v220
    v_mul_f32 v221, v7, v221
    v_mul_f32 v222, v7, v222
    v_mul_f32 v223, v7, v223
    v_mul_f32 v224, v7, v224
    v_mul_f32 v225, v7, v225
    v_mul_f32 v226, v7, v226
    v_mul_f32 v227, v7, v227
    v_mul_f32 v228, v7, v228
    v_mul_f32 v229, v7, v229
    v_mul_f32 v230, v7, v230
    v_mul_f32 v231, v7, v231
    v_mul_f32 v232, v7, v232
    v_mul_f32 v233, v7, v233
    v_mul_f32 v234, v7, v234
    v_mul_f32 v235, v7, v235
    v_mul_f32 v236, v7, v236
    v_mul_f32 v237, v7, v237
    v_mul_f32 v238, v7, v238
    v_mul_f32 v239, v7, v239
    v_mul_f32 v240, v7, v240
    v_mul_f32 v241, v7, v241
    v_mul_f32 v242, v7, v242
    v_mul_f32 v243, v7, v243
    v_mul_f32 v244, v7, v244
    v_mul_f32 v245, v7, v245
    v_mul_f32 v246, v7, v246
    v_mul_f32 v247, v7, v247
    v_mul_f32 v248, v7, v248
    v_mul_f32 v249, v7, v249
    v_mul_f32 v250, v7, v250
    v_mul_f32 v251, v7, v251
    v_mul_f32 v252, v7, v252
    v_mul_f32 v253, v7, v253
    v_mul_f32 v254, v7, v254
    v_mul_f32 v255, v7, v255
L_skip_final_1:
    s_waitcnt vmcnt(4)
    s_add_u32 m0, s78, 0
    s_nop 0
    buffer_load_dwordx4 v2, s[28:31], s38 offen offset:3072 nt lds
    s_waitcnt vmcnt(4)
    s_add_u32 m0, s78, 4096
    s_nop 0
    buffer_load_dwordx4 v2, s[28:31], s39 offen offset:0 nt lds
    v_perm_b32 v48, v68, v64, s63
    v_perm_b32 v49, v76, v72, s63
    v_perm_b32 v50, v84, v80, s63
    v_perm_b32 v51, v92, v88, s63
    v_perm_b32 v52, v68, v64, s64
    v_perm_b32 v53, v76, v72, s64
    v_perm_b32 v54, v84, v80, s64
    v_perm_b32 v55, v92, v88, s64
    s_nop 1
    v_mfma_f32_32x32x16_bf16 v[128:143], v[48:51], v[24:27], v[128:143]
    v_mfma_f32_32x32x16_bf16 v[144:159], v[52:55], v[24:27], v[144:159]
    v_perm_b32 v56, v69, v65, s63
    v_perm_b32 v57, v77, v73, s63
    v_perm_b32 v58, v85, v81, s63
    v_perm_b32 v59, v93, v89, s63
    v_perm_b32 v60, v69, v65, s64
    v_perm_b32 v61, v77, v73, s64
    v_perm_b32 v62, v85, v81, s64
    v_perm_b32 v63, v93, v89, s64
    s_nop 1
    v_mfma_f32_32x32x16_bf16 v[160:175], v[56:59], v[24:27], v[160:175]
    v_mfma_f32_32x32x16_bf16 v[176:191], v[60:63], v[24:27], v[176:191]
    s_waitcnt vmcnt(4)
    s_add_u32 m0, s78, 4096
    s_nop 0
    buffer_load_dwordx4 v2, s[28:31], s39 offen offset:1024 nt lds
    v_perm_b32 v48, v70, v66, s63
    v_perm_b32 v49, v78, v74, s63
    v_perm_b32 v50, v86, v82, s63
    v_perm_b32 v51, v94, v90, s63
    v_perm_b32 v52, v70, v66, s64
    v_perm_b32 v53, v78, v74, s64
    v_perm_b32 v54, v86, v82, s64
    v_perm_b32 v55, v94, v90, s64
    s_nop 1
    v_mfma_f32_32x32x16_bf16 v[192:207], v[48:51], v[24:27], v[192:207]
    v_mfma_f32_32x32x16_bf16 v[208:223], v[52:55], v[24:27], v[208:223]
    v_perm_b32 v56, v71, v67, s63
    v_perm_b32 v57, v79, v75, s63
    v_perm_b32 v58, v87, v83, s63
    v_perm_b32 v59, v95, v91, s63
    v_perm_b32 v60, v71, v67, s64
    v_perm_b32 v61, v79, v75, s64
    v_perm_b32 v62, v87, v83, s64
    v_perm_b32 v63, v95, v91, s64
    s_nop 1
    v_mfma_f32_32x32x16_bf16 v[224:239], v[56:59], v[24:27], v[224:239]
    v_mfma_f32_32x32x16_bf16 v[240:255], v[60:63], v[24:27], v[240:255]
    s_waitcnt vmcnt(4)
    s_add_u32 m0, s78, 4096
    s_nop 0
    buffer_load_dwordx4 v2, s[28:31], s39 offen offset:2048 nt lds
    s_nop 7
    s_cmp_eq_u32 s22, 0
    s_cbranch_scc1 L_nopart0
    s_sub_u32 s40, 3, s22
    s_and_b32 s40, s40, 3
    s_lshl_b32 s41, s40, 13
    s_add_u32 s41, s41, s60
    s_lshl_b32 s42, s22, 13
    s_add_u32 s42, s42, 66560
    s_cmp_eq_u32 s40, 2
    s_cselect_b32 s41, s42, s41
    v_add_u32 v15, s41, v2
    ds_write_b128 v15, v[128:131] offset:0
    ds_write_b128 v15, v[144:147] offset:1024
    ds_write_b128 v15, v[160:163] offset:2048
    ds_write_b128 v15, v[176:179] offset:3072
    ds_write_b128 v15, v[192:195] offset:4096
    ds_write_b128 v15, v[208:211] offset:5120
    ds_write_b128 v15, v[224:227] offset:6144
    ds_write_b128 v15, v[240:243] offset:7168
L_nopart0:
    s_cmp_eq_u32 s22, 1
    s_cbranch_scc1 L_nopart1
    s_sub_u32 s40, 4, s22
    s_and_b32 s40, s40, 3
    s_lshl_b32 s41, s40, 13
    s_add_u32 s41, s41, s60
    s_lshl_b32 s42, s22, 13
    s_add_u32 s42, s42, 66560
    s_cmp_eq_u32 s40, 2
    s_cselect_b32 s41, s42, s41
    v_add_u32 v15, s41, v2
    ds_write_b128 v15, v[132:135] offset:0
    ds_write_b128 v15, v[148:151] offset:1024
    ds_write_b128 v15, v[164:167] offset:2048
    ds_write_b128 v15, v[180:183] offset:3072
    ds_write_b128 v15, v[196:199] offset:4096
    ds_write_b128 v15, v[212:215] offset:5120
    ds_write_b128 v15, v[228:231] offset:6144
    ds_write_b128 v15, v[244:247] offset:7168
L_nopart1:
    s_waitcnt vmcnt(4)
    s_add_u32 m0, s78, 4096
    s_nop 0
    buffer_load_dwordx4 v2, s[28:31], s39 offen offset:3072 nt lds
    s_cmp_eq_u32 s22, 2
    s_cbranch_scc1 L_nopart2
    s_sub_u32 s40, 5, s22
    s_and_b32 s40, s40, 3
    s_lshl_b32 s41, s40, 13
    s_add_u32 s41, s41, s60
    s_lshl_b32 s42, s22, 13
    s_add_u32 s42, s42, 66560
    s_cmp_eq_u32 s40, 2
    s_cselect_b32 s41, s42, s41
    v_add_u32 v15, s41, v2
    ds_write_b128 v15, v[136:139] offset:0
    ds_write_b128 v15, v[152:155] offset:1024
    ds_write_b128 v15, v[168:171] offset:2048
    ds_write_b128 v15, v[184:187] offset:3072
    ds_write_b128 v15, v[200:203] offset:4096
    ds_write_b128 v15, v[216:219] offset:5120
    ds_write_b128 v15, v[232:235] offset:6144
    ds_write_b128 v15, v[248:251] offset:7168
L_nopart2:
    s_cmp_eq_u32 s22, 3
    s_cbranch_scc1 L_nopart3
    s_sub_u32 s40, 6, s22
    s_and_b32 s40, s40, 3
    s_lshl_b32 s41, s40, 13
    s_add_u32 s41, s41, s60
    s_lshl_b32 s42, s22, 13
    s_add_u32 s42, s42, 66560
    s_cmp_eq_u32 s40, 2
    s_cselect_b32 s41, s42, s41
    v_add_u32 v15, s41, v2
    ds_write_b128 v15, v[140:143] offset:0
    ds_write_b128 v15, v[156:159] offset:1024
    ds_write_b128 v15, v[172:175] offset:2048
    ds_write_b128 v15, v[188:191] offset:3072
    ds_write_b128 v15, v[204:207] offset:4096
    ds_write_b128 v15, v[220:223] offset:5120
    ds_write_b128 v15, v[236:239] offset:6144
    ds_write_b128 v15, v[252:255] offset:7168
L_nopart3:
    v_readfirstlane_b32 s80, v19
    s_mov_b32 s23, 0
    s_cmp_lg_u32 s82, 2
    s_cbranch_scc1 L_nopref
    s_cmp_lg_u32 s80, 1
    s_cbranch_scc1 L_again
    s_mov_b32 s23, 1
    s_lshl_b32 s80, s22, 13
    s_add_u32 s80, s80, s66
    s_lshl_b32 s81, s22, 9
    s_add_u32 s81, s81, s66
    s_add_u32 s81, s81, 32768
    buffer_load_dwordx2 v[16:17], v14, s[52:55], s81 offen sc1
    buffer_load_dwordx4 v[64:67], v2, s[52:55], s80 offen offset:0 sc1
    buffer_load_dwordx4 v[68:71], v2, s[52:55], s80 offen offset:1024 sc1
    buffer_load_dwordx4 v[72:75], v2, s[52:55], s80 offen offset:2048 sc1
    buffer_load_dwordx4 v[76:79], v2, s[52:55], s80 offen offset:3072 sc1
    buffer_load_dwordx4 v[80:83], v21, s[52:55], s80 offen offset:0 sc1
    buffer_load_dwordx4 v[84:87], v21, s[52:55], s80 offen offset:1024 sc1
    buffer_load_dwordx4 v[88:91], v21, s[52:55], s80 offen offset:2048 sc1
    buffer_load_dwordx4 v[92:95], v21, s[52:55], s80 offen offset:3072 sc1
    s_branch L_nopref
L_again:
    s_mov_b32 s23, 2
    buffer_load_dword v19, v20, s[52:55], s66 offen sc1
L_nopref:
    s_waitcnt lgkmcnt(0)
    s_barrier
    s_sub_u32 s78, s22, 1
    s_and_b32 s78, s78, 3
    s_mul_i32 s79, s78, 16640
    s_add_u32 s79, s79, 0
    v_add_u32 v15, s79, v2
    ds_read_b128 v[32:35], v15 offset:0
    ds_read_b128 v[36:39], v15 offset:1024
    ds_read_b128 v[40:43], v15 offset:2048
    ds_read_b128 v[44:47], v15 offset:3072
    ds_read_b128 v[48:51], v15 offset:4096
    ds_read_b128 v[52:55], v15 offset:5120
    ds_read_b128 v[56:59], v15 offset:6144
    ds_read_b128 v[60:63], v15 offset:7168
    ds_read_b32 v24, v22 offset:4
    ds_read_b32 v25, v22 offset:516
    ds_read_b32 v26, v22 offset:1028
    ds_read_b32 v27, v22 offset:1540
    s_waitcnt lgkmcnt(4)
    s_cmp_lg_u32 s22, 0
    s_cbranch_scc1 L_own1
    v_pk_add_f32 v[96:97], v[128:129], v[32:33]
    v_pk_add_f32 v[98:99], v[130:131], v[34:35]
    v_pk_add_f32 v[112:113], v[144:145], v[36:37]
    v_pk_add_f32 v[114:115], v[146:147], v[38:39]
    v_pk_add_f32 v[100:101], v[160:161], v[40:41]
    v_pk_add_f32 v[102:103], v[162:163], v[42:43]
    v_pk_add_f32 v[116:117], v[176:177], v[44:45]
    v_pk_add_f32 v[118:119], v[178:179], v[46:47]
    v_pk_add_f32 v[104:105], v[192:193], v[48:49]
    v_pk_add_f32 v[106:107], v[194:195], v[50:51]
    v_pk_add_f32 v[120:121], v[208:209], v[52:53]
    v_pk_add_f32 v[122:123], v[210:211], v[54:55]
    v_pk_add_f32 v[108:109], v[224:225], v[56:57]
    v_pk_add_f32 v[110:111], v[226:227], v[58:59]
    v_pk_add_f32 v[124:125], v[240:241], v[60:61]
    v_pk_add_f32 v[126:127], v[242:243], v[62:63]
    s_branch L_owndone
L_own1:
    s_cmp_lg_u32 s22, 1
    s_cbranch_scc1 L_own2
    v_pk_add_f32 v[96:97], v[132:133], v[32:33]
    v_pk_add_f32 v[98:99], v[134:135], v[34:35]
    v_pk_add_f32 v[112:113], v[148:149], v[36:37]
    v_pk_add_f32 v[114:115], v[150:151], v[38:39]
    v_pk_add_f32 v[100:101], v[164:165], v[40:41]
    v_pk_add_f32 v[102:103], v[166:167], v[42:43]
    v_pk_add_f32 v[116:117], v[180:181], v[44:45]
    v_pk_add_f32 v[118:119], v[182:183], v[46:47]
    v_pk_add_f32 v[104:105], v[196:197], v[48:49]
    v_pk_add_f32 v[106:107], v[198:199], v[50:51]
    v_pk_add_f32 v[120:121], v[212:213], v[52:53]
    v_pk_add_f32 v[122:123], v[214:215], v[54:55]
    v_pk_add_f32 v[108:109], v[228:229], v[56:57]
    v_pk_add_f32 v[110:111], v[230:231], v[58:59]
    v_pk_add_f32 v[124:125], v[244:245], v[60:61]
    v_pk_add_f32 v[126:127], v[246:247], v[62:63]
    s_branch L_owndone
L_own2:
    s_cmp_lg_u32 s22, 2
    s_cbranch_scc1 L_own3
    v_pk_add_f32 v[96:97], v[136:137], v[32:33]
    v_pk_add_f32 v[98:99], v[138:139], v[34:35]
    v_pk_add_f32 v[112:113], v[152:153], v[36:37]
    v_pk_add_f32 v[114:115], v[154:155], v[38:39]
    v_pk_add_f32 v[100:101], v[168:169], v[40:41]
    v_pk_add_f32 v[102:103], v[170:171], v[42:43]
    v_pk_add_f32 v[116:117], v[184:185], v[44:45]
    v_pk_add_f32 v[118:119], v[186:187], v[46:47]
    v_pk_add_f32 v[104:105], v[200:201], v[48:49]
    v_pk_add_f32 v[106:107], v[202:203], v[50:51]
    v_pk_add_f32 v[120:121], v[216:217], v[52:53]
    v_pk_add_f32 v[122:123], v[218:219], v[54:55]
    v_pk_add_f32 v[108:109], v[232:233], v[56:57]
    v_pk_add_f32 v[110:111], v[234:235], v[58:59]
    v_pk_add_f32 v[124:125], v[248:249], v[60:61]
    v_pk_add_f32 v[126:127], v[250:251], v[62:63]
    s_branch L_owndone
L_own3:
    v_pk_add_f32 v[96:97], v[140:141], v[32:33]
    v_pk_add_f32 v[98:99], v[142:143], v[34:35]
    v_pk_add_f32 v[112:113], v[156:157], v[36:37]
    v_pk_add_f32 v[114:115], v[158:159], v[38:39]
    v_pk_add_f32 v[100:101], v[172:173], v[40:41]
    v_pk_add_f32 v[102:103], v[174:175], v[42:43]
    v_pk_add_f32 v[116:117], v[188:189], v[44:45]
    v_pk_add_f32 v[118:119], v[190:191], v[46:47]
    v_pk_add_f32 v[104:105], v[204:205], v[48:49]
    v_pk_add_f32 v[106:107], v[206:207], v[50:51]
    v_pk_add_f32 v[120:121], v[220:221], v[52:53]
    v_pk_add_f32 v[122:123], v[222:223], v[54:55]
    v_pk_add_f32 v[108:109], v[236:237], v[56:57]
    v_pk_add_f32 v[110:111], v[238:239], v[58:59]
    v_pk_add_f32 v[124:125], v[252:253], v[60:61]
    v_pk_add_f32 v[126:127], v[254:255], v[62:63]
L_owndone:
    s_sub_u32 s78, s22, 2
    s_and_b32 s78, s78, 3
    s_mul_i32 s79, s78, 16640
    s_add_u32 s79, s79, 8192
    v_add_u32 v15, s79, v2
    ds_read_b128 v[128:131], v15 offset:0
    ds_read_b128 v[132:135], v15 offset:1024
    ds_read_b128 v[136:139], v15 offset:2048
    ds_read_b128 v[140:143], v15 offset:3072
    ds_read_b128 v[144:147], v15 offset:4096
    ds_read_b128 v[148:151], v15 offset:5120
    ds_read_b128 v[152:155], v15 offset:6144
    ds_read_b128 v[156:159], v15 offset:7168
    s_waitcnt lgkmcnt(8)
    v_add_f32 v11, v24, v25
    v_add_f32 v12, v26, v27
    v_mov_b32 v10, v5
    v_add_f32 v11, v11, v12
    s_sub_u32 s78, s22, 3
    s_and_b32 s78, s78, 3
    s_lshl_b32 s79, s78, 13
    s_add_u32 s79, s79, 66560
    v_add_u32 v15, s79, v2
    s_waitcnt lgkmcnt(7)
    ds_read_b128 v[160:163], v15 offset:0
    ds_read_b128 v[164:167], v15 offset:1024
    ds_read_b128 v[168:171], v15 offset:2048
    ds_read_b128 v[172:175], v15 offset:3072
    ds_read_b128 v[176:179], v15 offset:4096
    ds_read_b128 v[180:183], v15 offset:5120
    ds_read_b128 v[184:187], v15 offset:6144
    ds_read_b128 v[188:191], v15 offset:7168
    s_waitcnt lgkmcnt(8)
    v_pk_add_f32 v[96:97], v[96:97], v[128:129]
    v_pk_add_f32 v[98:99], v[98:99], v[130:131]
    v_pk_add_f32 v[112:113], v[112:113], v[132:133]
    v_pk_add_f32 v[114:115], v[114:115], v[134:135]
    v_pk_add_f32 v[100:101], v[100:101], v[136:137]
    v_pk_add_f32 v[102:103], v[102:103], v[138:139]
    v_pk_add_f32 v[116:117], v[116:117], v[140:141]
    v_pk_add_f32 v[118:119], v[118:119], v[142:143]
    v_pk_add_f32 v[104:105], v[104:105], v[144:145]
    v_pk_add_f32 v[106:107], v[106:107], v[146:147]
    v_pk_add_f32 v[120:121], v[120:121], v[148:149]
    v_pk_add_f32 v[122:123], v[122:123], v[150:151]
    v_pk_add_f32 v[108:109], v[108:109], v[152:153]
    v_pk_add_f32 v[110:111], v[110:111], v[154:155]
    v_pk_add_f32 v[124:125], v[124:125], v[156:157]
    v_pk_add_f32 v[126:127], v[126:127], v[158:159]
    v_add_u32 v12, 135168, v2
    ds_read_b128 v[224:227], v12 offset:0
    ds_read_b128 v[228:231], v12 offset:1024
    ds_read_b128 v[232:235], v12 offset:2048
    ds_read_b128 v[236:239], v12 offset:3072
    s_waitcnt lgkmcnt(4)
    v_pk_add_f32 v[96:97], v[96:97], v[160:161]
    v_pk_add_f32 v[98:99], v[98:99], v[162:163]
    v_pk_add_f32 v[112:113], v[112:113], v[164:165]
    v_pk_add_f32 v[114:115], v[114:115], v[166:167]
    v_pk_add_f32 v[100:101], v[100:101], v[168:169]
    v_pk_add_f32 v[102:103], v[102:103], v[170:171]
    v_pk_add_f32 v[116:117], v[116:117], v[172:173]
    v_pk_add_f32 v[118:119], v[118:119], v[174:175]
    v_pk_add_f32 v[104:105], v[104:105], v[176:177]
    v_pk_add_f32 v[106:107], v[106:107], v[178:179]
    v_pk_add_f32 v[120:121], v[120:121], v[180:181]
    v_pk_add_f32 v[122:123], v[122:123], v[182:183]
    v_pk_add_f32 v[108:109], v[108:109], v[184:185]
    v_pk_add_f32 v[110:111], v[110:111], v[186:187]
    v_pk_add_f32 v[124:125], v[124:125], v[188:189]
    v_pk_add_f32 v[126:127], v[126:127], v[190:191]
    s_waitcnt vmcnt(0) lgkmcnt(0)
    s_barrier
    ds_read_b32 v192, v23 offset:0
    ds_read_b32 v193, v23 offset:1024
    ds_read_b32 v194, v23 offset:2048
    ds_read_b32 v195, v23 offset:3072
    ds_read_b32 v196, v23 offset:4096
    ds_read_b32 v197, v23 offset:5120
    ds_read_b32 v198, v23 offset:6144
    ds_read_b32 v199, v23 offset:7168
    s_cmp_lg_u32 s23, 2
    s_cbranch_scc1 L_nosecond
    v_readfirstlane_b32 s80, v19
    s_mov_b32 s23, 0
    s_cmp_lg_u32 s80, 1
    s_cbranch_scc1 L_nosecond
    s_mov_b32 s23, 1
    s_lshl_b32 s80, s22, 13
    s_add_u32 s80, s80, s66
    s_lshl_b32 s81, s22, 9
    s_add_u32 s81, s81, s66
    s_add_u32 s81, s81, 32768
    buffer_load_dwordx2 v[16:17], v14, s[52:55], s81 offen sc1
    buffer_load_dwordx4 v[64:67], v2, s[52:55], s80 offen offset:0 sc1
    buffer_load_dwordx4 v[68:71], v2, s[52:55], s80 offen offset:1024 sc1
    buffer_load_dwordx4 v[72:75], v2, s[52:55], s80 offen offset:2048 sc1
    buffer_load_dwordx4 v[76:79], v2, s[52:55], s80 offen offset:3072 sc1
    buffer_load_dwordx4 v[80:83], v21, s[52:55], s80 offen offset:0 sc1
    buffer_load_dwordx4 v[84:87], v21, s[52:55], s80 offen offset:1024 sc1
    buffer_load_dwordx4 v[88:91], v21, s[52:55], s80 offen offset:2048 sc1
    buffer_load_dwordx4 v[92:95], v21, s[52:55], s80 offen offset:3072 sc1
L_nosecond:
    s_waitcnt lgkmcnt(7)
    ds_read_b32 v200, v23 offset:8192
    ds_read_b32 v201, v23 offset:9216
    ds_read_b32 v202, v23 offset:10240
    ds_read_b32 v203, v23 offset:11264
    ds_read_b32 v204, v23 offset:12288
    ds_read_b32 v205, v23 offset:13312
    ds_read_b32 v206, v23 offset:14336
    ds_read_b32 v207, v23 offset:15360
    s_waitcnt lgkmcnt(8)
    v_perm_b32 v240, v193, v192, s63
    v_perm_b32 v241, v195, v194, s63
    v_perm_b32 v242, v197, v196, s63
    v_perm_b32 v243, v199, v198, s63
    v_perm_b32 v244, v193, v192, s64
    v_perm_b32 v245, v195, v194, s64
    v_perm_b32 v246, v197, v196, s64
    v_perm_b32 v247, v199, v198, s64
    s_nop 1
    v_mfma_f32_32x32x16_bf16 v[96:111], v[240:243], v[224:227], v[96:111]
    v_mfma_f32_32x32x16_bf16 v[112:127], v[244:247], v[224:227], v[112:127]
    s_waitcnt lgkmcnt(7)
    ds_read_b32 v208, v23 offset:16384
    ds_read_b32 v209, v23 offset:17408
    ds_read_b32 v210, v23 offset:18432
    ds_read_b32 v211, v23 offset:19456
    ds_read_b32 v212, v23 offset:20480
    ds_read_b32 v213, v23 offset:21504
    ds_read_b32 v214, v23 offset:22528
    ds_read_b32 v215, v23 offset:23552
    s_waitcnt lgkmcnt(8)
    v_perm_b32 v248, v201, v200, s63
    v_perm_b32 v249, v203, v202, s63
    v_perm_b32 v250, v205, v204, s63
    v_perm_b32 v251, v207, v206, s63
    v_perm_b32 v252, v201, v200, s64
    v_perm_b32 v253, v203, v202, s64
    v_perm_b32 v254, v205, v204, s64
    v_perm_b32 v255, v207, v206, s64
    s_nop 1
    v_mfma_f32_32x32x16_bf16 v[96:111], v[248:251], v[228:231], v[96:111]
    v_mfma_f32_32x32x16_bf16 v[112:127], v[252:255], v[228:231], v[112:127]
    s_waitcnt lgkmcnt(7)
    ds_read_b32 v216, v23 offset:24576
    ds_read_b32 v217, v23 offset:25600
    ds_read_b32 v218, v23 offset:26624
    ds_read_b32 v219, v23 offset:27648
    ds_read_b32 v220, v23 offset:28672
    ds_read_b32 v221, v23 offset:29696
    ds_read_b32 v222, v23 offset:30720
    ds_read_b32 v223, v23 offset:31744
    s_waitcnt lgkmcnt(8)
    v_perm_b32 v240, v209, v208, s63
    v_perm_b32 v241, v211, v210, s63
    v_perm_b32 v242, v213, v212, s63
    v_perm_b32 v243, v215, v214, s63
    v_perm_b32 v244, v209, v208, s64
    v_perm_b32 v245, v211, v210, s64
    v_perm_b32 v246, v213, v212, s64
    v_perm_b32 v247, v215, v214, s64
    s_nop 1
    v_mfma_f32_32x32x16_bf16 v[96:111], v[240:243], v[232:235], v[96:111]
    v_mfma_f32_32x32x16_bf16 v[112:127], v[244:247], v[232:235], v[112:127]
    s_waitcnt lgkmcnt(0)
    v_perm_b32 v248, v217, v216, s63
    v_perm_b32 v249, v219, v218, s63
    v_perm_b32 v250, v221, v220, s63
    v_perm_b32 v251, v223, v222, s63
    v_perm_b32 v252, v217, v216, s64
    v_perm_b32 v253, v219, v218, s64
    v_perm_b32 v254, v221, v220, s64
    v_perm_b32 v255, v223, v222, s64
    s_nop 1
    v_mfma_f32_32x32x16_bf16 v[96:111], v[248:251], v[236:239], v[96:111]
    v_mfma_f32_32x32x16_bf16 v[112:127], v[252:255], v[236:239], v[112:127]
    s_nop 15
    s_cmp_lg_u32 s82, 1
    s_cbranch_scc1 L_second
    s_lshl_b32 s78, s22, 13
    s_add_u32 s78, s78, s65
    s_lshl_b32 s79, s22, 9
    s_add_u32 s79, s79, s65
    s_add_u32 s79, s79, 32768
    buffer_store_dwordx4 v[96:99], v2, s[52:55], s78 offen offset:0 sc1
    buffer_store_dwordx4 v[100:103], v2, s[52:55], s78 offen offset:1024 sc1
    buffer_store_dwordx4 v[104:107], v2, s[52:55], s78 offen offset:2048 sc1
    buffer_store_dwordx4 v[108:111], v2, s[52:55], s78 offen offset:3072 sc1
    buffer_store_dwordx4 v[112:115], v21, s[52:55], s78 offen offset:0 sc1
    buffer_store_dwordx4 v[116:119], v21, s[52:55], s78 offen offset:1024 sc1
    buffer_store_dwordx4 v[120:123], v21, s[52:55], s78 offen offset:2048 sc1
    buffer_store_dwordx4 v[124:127], v21, s[52:55], s78 offen offset:3072 sc1
    buffer_store_dwordx2 v[10:11], v14, s[52:55], s79 offen sc1
    v_mov_b32 v19, 1
    s_waitcnt vmcnt(0)
    s_mov_b64 exec, 1
    buffer_store_dword v19, v20, s[52:55], s65 offen sc1
    s_mov_b64 exec, -1
    s_branch L_fin
L_second:
    s_cmp_eq_u32 s23, 1
    s_cbranch_scc1 L_have
    s_mov_b32 s80, 4194304
L_poll:
    buffer_load_dword v19, v20, s[52:55], s66 offen sc1
    s_waitcnt vmcnt(0)
    v_readfirstlane_b32 s81, v19
    s_sub_u32 s80, s80, 1
    s_cmp_eq_u32 s80, 0
    s_cbranch_scc1 L_got
    s_cmp_eq_u32 s81, 1
    s_cbranch_scc1 L_got
    s_sleep 1
    s_branch L_poll
L_got:
    s_lshl_b32 s80, s22, 13
    s_add_u32 s80, s80, s66
    s_lshl_b32 s81, s22, 9
    s_add_u32 s81, s81, s66
    s_add_u32 s81, s81, 32768
    buffer_load_dwordx2 v[16:17], v14, s[52:55], s81 offen sc1
    buffer_load_dwordx4 v[64:67], v2, s[52:55], s80 offen offset:0 sc1
    buffer_load_dwordx4 v[68:71], v2, s[52:55], s80 offen offset:1024 sc1
    buffer_load_dwordx4 v[72:75], v2, s[52:55], s80 offen offset:2048 sc1
    buffer_load_dwordx4 v[76:79], v2, s[52:55], s80 offen offset:3072 sc1
    buffer_load_dwordx4 v[80:83], v21, s[52:55], s80 offen offset:0 sc1
    buffer_load_dwordx4 v[84:87], v21, s[52:55], s80 offen offset:1024 sc1
    buffer_load_dwordx4 v[88:91], v21, s[52:55], s80 offen offset:2048 sc1
    buffer_load_dwordx4 v[92:95], v21, s[52:55], s80 offen offset:3072 sc1
L_have:
    s_waitcnt vmcnt(0)
    v_max_f32 v12, v10, v16
    v_sub_f32 v10, v10, v12
    v_sub_f32 v16, v16, v12
    v_exp_f32 v10, v10
    v_exp_f32 v16, v16
    s_nop 0
    v_mul_f32 v11, v11, v10
    v_fmac_f32 v11, v17, v16
    v_rcp_f32 v11, v11
    s_nop 0
    v_mul_f32 v10, v10, v11
    v_mul_f32 v16, v16, v11
    s_lshl_b32 s78, s22, 7
    s_mul_i32 s79, s22, 4608
    s_add_u32 s79, s79, 139264
    v_lshrrev_b32 v12, 9, v18
    v_mul_u32_u24 v12, 144, v12
    v_and_b32 v13, 64, v18
    v_add3_u32 v12, v12, v13, s79
    v_lshrrev_b32 v13, 3, v1
    v_mul_u32_u24 v15, 144, v13
    v_and_b32 v9, 7, v1
    v_lshlrev_b32 v9, 4, v9
    v_add3_u32 v15, v15, v9, s79
    v_lshl_add_u32 v13, v13, 9, v9
    v_pk_mul_f32 v[96:97], v[10:11], v[96:97] op_sel_hi:[0,1]
    v_pk_mul_f32 v[112:113], v[10:11], v[112:113] op_sel_hi:[0,1]
    v_pk_mul_f32 v[100:101], v[10:11], v[100:101] op_sel_hi:[0,1]
    v_pk_mul_f32 v[116:117], v[10:11], v[116:117] op_sel_hi:[0,1]
    v_pk_mul_f32 v[104:105], v[10:11], v[104:105] op_sel_hi:[0,1]
    v_pk_mul_f32 v[120:121], v[10:11], v[120:121] op_sel_hi:[0,1]
    v_pk_mul_f32 v[108:109], v[10:11], v[108:109] op_sel_hi:[0,1]
    v_pk_mul_f32 v[124:125], v[10:11], v[124:125] op_sel_hi:[0,1]
    v_pk_fma_f32 v[96:97], v[16:17], v[64:65], v[96:97] op_sel_hi:[0,1,1]
    v_pk_fma_f32 v[112:113], v[16:17], v[80:81], v[112:113] op_sel_hi:[0,1,1]
    v_pk_fma_f32 v[100:101], v[16:17], v[68:69], v[100:101] op_sel_hi:[0,1,1]
    v_pk_fma_f32 v[116:117], v[16:17], v[84:85], v[116:117] op_sel_hi:[0,1,1]
    v_pk_fma_f32 v[104:105], v[16:17], v[72:73], v[104:105] op_sel_hi:[0,1,1]
    v_pk_fma_f32 v[120:121], v[16:17], v[88:89], v[120:121] op_sel_hi:[0,1,1]
    v_pk_fma_f32 v[108:109], v[16:17], v[76:77], v[108:109] op_sel_hi:[0,1,1]
    v_pk_fma_f32 v[124:125], v[16:17], v[92:93], v[124:125] op_sel_hi:[0,1,1]
    v_cvt_pk_bf16_f32 v32, v96, v112
    v_cvt_pk_bf16_f32 v33, v100, v116
    v_cvt_pk_bf16_f32 v34, v104, v120
    v_cvt_pk_bf16_f32 v35, v108, v124
    ds_write_b128 v12, v[32:35] offset:0
    v_cvt_pk_bf16_f32 v36, v97, v113
    v_cvt_pk_bf16_f32 v37, v101, v117
    v_cvt_pk_bf16_f32 v38, v105, v121
    v_cvt_pk_bf16_f32 v39, v109, v125
    ds_write_b128 v12, v[36:39] offset:16
    v_pk_mul_f32 v[98:99], v[10:11], v[98:99] op_sel_hi:[0,1]
    v_pk_mul_f32 v[114:115], v[10:11], v[114:115] op_sel_hi:[0,1]
    v_pk_mul_f32 v[102:103], v[10:11], v[102:103] op_sel_hi:[0,1]
    v_pk_mul_f32 v[118:119], v[10:11], v[118:119] op_sel_hi:[0,1]
    v_pk_mul_f32 v[106:107], v[10:11], v[106:107] op_sel_hi:[0,1]
    v_pk_mul_f32 v[122:123], v[10:11], v[122:123] op_sel_hi:[0,1]
    v_pk_mul_f32 v[110:111], v[10:11], v[110:111] op_sel_hi:[0,1]
    v_pk_mul_f32 v[126:127], v[10:11], v[126:127] op_sel_hi:[0,1]
    v_pk_fma_f32 v[98:99], v[16:17], v[66:67], v[98:99] op_sel_hi:[0,1,1]
    v_pk_fma_f32 v[114:115], v[16:17], v[82:83], v[114:115] op_sel_hi:[0,1,1]
    v_pk_fma_f32 v[102:103], v[16:17], v[70:71], v[102:103] op_sel_hi:[0,1,1]
    v_pk_fma_f32 v[118:119], v[16:17], v[86:87], v[118:119] op_sel_hi:[0,1,1]
    v_pk_fma_f32 v[106:107], v[16:17], v[74:75], v[106:107] op_sel_hi:[0,1,1]
    v_pk_fma_f32 v[122:123], v[16:17], v[90:91], v[122:123] op_sel_hi:[0,1,1]
    v_pk_fma_f32 v[110:111], v[16:17], v[78:79], v[110:111] op_sel_hi:[0,1,1]
    v_pk_fma_f32 v[126:127], v[16:17], v[94:95], v[126:127] op_sel_hi:[0,1,1]
    v_cvt_pk_bf16_f32 v40, v98, v114
    v_cvt_pk_bf16_f32 v41, v102, v118
    v_cvt_pk_bf16_f32 v42, v106, v122
    v_cvt_pk_bf16_f32 v43, v110, v126
    ds_write_b128 v12, v[40:43] offset:32
    v_cvt_pk_bf16_f32 v44, v99, v115
    v_cvt_pk_bf16_f32 v45, v103, v119
    v_cvt_pk_bf16_f32 v46, v107, v123
    v_cvt_pk_bf16_f32 v47, v111, v127
    ds_write_b128 v12, v[44:47] offset:48
    s_waitcnt lgkmcnt(0)
    ds_read_b128 v[48:51], v15 offset:0
    ds_read_b128 v[52:55], v15 offset:1152
    ds_read_b128 v[56:59], v15 offset:2304
    ds_read_b128 v[60:63], v15 offset:3456
    s_add_u32 s79, s78, 4096
    s_add_u32 s80, s78, 8192
    s_add_u32 s81, s78, 12288
    s_waitcnt lgkmcnt(3)
    buffer_store_dwordx4 v[48:51], v13, s[48:51], s78 offen nt
    s_waitcnt lgkmcnt(2)
    buffer_store_dwordx4 v[52:55], v13, s[48:51], s79 offen nt
    s_waitcnt lgkmcnt(1)
    buffer_store_dwordx4 v[56:59], v13, s[48:51], s80 offen nt
    s_waitcnt lgkmcnt(0)
    buffer_store_dwordx4 v[60:63], v13, s[48:51], s81 offen nt
L_fin:
L_end:
    s_endpgm
.section .rodata,"a"
.p2align 6
.amdhsa_kernel standalone__tree_speculative_verify_tree_attention_over_candidate_token_tree__sampling_kernel
  .amdhsa_next_free_vgpr 384
  .amdhsa_next_free_sgpr 102
  .amdhsa_accum_offset 256
  .amdhsa_group_segment_fixed_size 0
  .amdhsa_kernarg_size 72
  .amdhsa_user_sgpr_count 2
  .amdhsa_user_sgpr_kernarg_segment_ptr 1
  .amdhsa_system_sgpr_workgroup_id_x 1
  .amdhsa_float_denorm_mode_32 3
.end_amdhsa_kernel
```
